```python
import torch

def _softmax(x, axis=-1):
    return torch.softmax(x, dim=axis)
def _gelu(x):
    return torch.nn.functional.gelu(x, approximate="tanh")
def _silu(x):
    return torch.nn.functional.silu(x)
def _sigmoid(x):
    return torch.sigmoid(x)
def _layernorm(x, axis=-1, eps=1e-5):
    m = x.mean(dim=axis, keepdim=True)
    v = x.var(dim=axis, keepdim=True, unbiased=False)
    return (x - m) / torch.sqrt(v + eps)
def _scatter_add(tgt, idx, src, axis=0):
    return tgt.clone().index_add_(axis, idx, src)
def _segment_sum(src, seg, n):
    out = torch.zeros((n,) + src.shape[1:], dtype=src.dtype)
    return out.index_add_(0, seg, src)
def _pad(x, pw):
    flat = tuple(v for pair in reversed(pw) for v in pair)
    return torch.nn.functional.pad(x, flat)

kernel_name = 'sequential_preLN__softmax_full_mha__dense_activation_gelu__prompt'

def setup_inputs():

    _w = (lambda a: (lambda t: t.to(torch.bfloat16) if t.is_floating_point() else t)(torch.as_tensor(a)))
    def _A_setup():
        B, S, D = 1, 2048, 512
        return {
            "x": _w((lambda *s: torch.randn(*s, dtype=torch.bfloat16) * 0.05)(B, S, D)),
            "wqkv": _w((lambda *s: torch.randn(*s, dtype=torch.bfloat16) * 0.05)(D, 3 * D)),
            "wo": _w((lambda *s: torch.randn(*s, dtype=torch.bfloat16) * 0.05)(D, D)),
        }
    _A_in = _A_setup()

    def _B_setup():
        B, S, D, F = 1, 2048, 512, 1376
        return {
            "x": _w((lambda *s: torch.randn(*s, dtype=torch.bfloat16) * 0.05)(B, S, D)),
            "w1": _w((lambda *s: torch.randn(*s, dtype=torch.bfloat16) * 0.8)(D, F) * (D ** -0.5)),
            "b1": _w((lambda *s: torch.randn(*s, dtype=torch.bfloat16) * 0.2)(F) * 0.01),
            "w2": _w((lambda *s: torch.randn(*s, dtype=torch.bfloat16) * 0.2)(F, D) * (F ** -0.5)),
            "b2": _w((lambda *s: torch.randn(*s, dtype=torch.bfloat16) * 0.2)(D) * 0.01),
        }
    _B_in = _B_setup()

    return {
        "A_x": _A_in["x"],
        "A_wqkv": _A_in["wqkv"],
        "A_wo": _A_in["wo"],
        "B_x": _B_in["x"],
        "B_w1": _B_in["w1"],
        "B_b1": _B_in["b1"],
        "B_w2": _B_in["w2"],
        "B_b2": _B_in["b2"],
    }

def reference(A_x, A_wqkv, A_wo, B_x, B_w1, B_b1, B_w2, B_b2):
    def _A_ref(x, wqkv, wo):
        B, S, D = x.shape
        H = 32; Dh = D // H
        qkv = (lambda x, *d: x.permute(*d))((x @ wqkv).reshape(B, S, 3, H, Dh), 2, 0, 3, 1, 4)
        q, k, v = qkv[0], qkv[1], qkv[2]
        scale = Dh ** -0.5
        scores = torch.einsum("bhqd,bhkd->bhqk", q, k) * scale
        p = _softmax(scores, axis=-1)
        o = torch.einsum("bhqk,bhkd->bhqd", p, v)
        return (lambda x, *d: x.permute(*d))(o, 0, 2, 1, 3).reshape(B, S, D) @ wo

    def _B_ref(x, w1, b1, w2, b2):
        h = torch.einsum("bsd,df->bsf", x, w1) + b1
        h = _gelu(h)
        return torch.einsum("bsf,fd->bsd", h, w2) + b2

    x = A_x
    h = x + _A_ref(_layernorm(x, axis=-1), A_wqkv, A_wo)
    h2 = h + _B_ref(_layernorm(h, axis=-1), B_w1, B_b1, B_w2, B_b2)
    return h2
```

```asm
; @launch grid=(256,1,1) block=(512,1,1) lds=163840
.amdgcn_target "amdgcn-amd-amdhsa--gfx950"
.text
.globl sequential_preLN__softmax_full_mha__dense_activation_gelu__prompt_kernel
.p2align 8
.type sequential_preLN__softmax_full_mha__dense_activation_gelu__prompt_kernel,@function
sequential_preLN__softmax_full_mha__dense_activation_gelu__prompt_kernel:
    s_cmp_ge_u32 s2, 0x100
    s_cbranch_scc1 L_end
    s_load_dwordx2 s[4:5], s[0:1], 0
    s_load_dwordx2 s[8:9], s[0:1], 8
    s_load_dwordx2 s[12:13], s[0:1], 80
    s_getpc_b64 s[20:21]
L_pc:
    s_mov_b32 s22, L_code_end-L_pc
    s_mov_b32 s23, 0x20000
    s_lshr_b32 s52, s2, 3
    s_mul_i32 s58, s52, 1280
    v_lshlrev_b32 v2, 7, v0
    v_cmp_gt_u32 vcc, 10, v0
    s_nop 1
    v_cndmask_b32 v2, 2.0, v2, vcc
    buffer_load_dword v3, v2, s[20:23], s58 offen
    v_lshrrev_b32 v5, 6, v0
    v_and_b32 v1, 63, v0
    v_readfirstlane_b32 s48, v5
    s_and_b32 s51, s2, 7
    s_lshr_b32 s52, s2, 3
    s_and_b32 s58, s52, 1
    s_lshl1_add_u32 s53, s51, s58
    s_lshr_b32 s54, s52, 1
    s_lshl2_add_u32 s69, s58, s54
    s_add_u32 s69, s69, s51
    s_and_b32 s49, s48, 3
    s_lshr_b32 s50, s48, 2
    s_mov_b32 s6, 0x200000
    s_mov_b32 s7, 0x20000
    s_mov_b32 s10, 0x180000
    s_mov_b32 s11, 0x20000
    s_mov_b32 s14, 16777216
    s_mov_b32 s15, 0x20000
    s_cmp_eq_u32 s50, 0
    s_cbranch_scc0 L_f1
    v_and_b32 v72, 31, v1
    v_lshlrev_b32 v72, 4, v72
    v_lshrrev_b32 v73, 5, v1
    v_lshl_add_u32 v74, v73, 10, v72
    s_lshl4_add_u32 s65, s53, s54
    s_lshl2_add_u32 s58, s65, s49
    s_lshl_b32 s58, s58, 11
    s_waitcnt lgkmcnt(0)
    buffer_load_dwordx4 v[64:67], v74, s[4:7], s58 offen
    buffer_load_dwordx4 v[68:71], v74, s[4:7], s58 offen offset:512
    s_branch L_f0
L_f1:
    v_lshrrev_b32 v6, 3, v1
    v_lshrrev_b32 v7, 4, v1
    v_xor_b32 v8, v1, v7
    v_and_b32 v8, 7, v8
    v_lshlrev_b32 v8, 4, v8
    v_lshl_add_u32 v96, v6, 10, v8
    v_xor_b32 v97, 0x2040, v96
    v_lshrrev_b32 v7, 2, v1
    v_and_b32 v7, 4, v7
    v_xor_b32 v7, v1, v7
    v_and_b32 v7, 7, v7
    v_lshlrev_b32 v7, 4, v7
    v_mul_u32_u24 v6, 0xc00, v6
    v_add_u32 v98, v6, v7
    s_lshl2_add_u32 s56, s53, s49
    s_lshl_b32 s56, s56, 15
    s_and_b32 s58, s54, 1
    s_lshr_b32 s59, s54, 1
    s_lshl3_add_u32 s58, s58, s59
    s_lshl_b32 s58, s58, 7
    s_mul_i32 s59, s49, 0xc000
    s_add_u32 s58, s58, s59
    s_add_u32 s57, s58, 0x400
    s_lshl_b32 s64, s49, 11
    s_lshl_b32 s65, s49, 12
    s_waitcnt lgkmcnt(0)
    s_load_dwordx2 s[46:47], s[12:13], 0
    s_add_u32 s58, s69, 0
    s_and_b32 s58, s58, 7
    s_mul_i32 s58, s58, 0x30000
    s_add_u32 m0, s64, 65536
    s_add_u32 s58, s58, s57
    buffer_load_dwordx4 v98, s[8:11], s58 offen lds
    s_add_u32 m0, s64, 66560
    s_add_u32 s58, s58, 0x6000
    buffer_load_dwordx4 v98, s[8:11], s58 offen lds
    s_add_u32 s58, s69, 0
    s_and_b32 s58, s58, 7
    s_lshl_b32 s58, s58, 7
    s_add_u32 m0, s65, 0
    s_add_u32 s58, s58, s56
    buffer_load_dwordx4 v96, s[4:7], s58 offen lds
    s_add_u32 m0, s65, 1024
    s_nop 0
    buffer_load_dwordx4 v97, s[4:7], s58 offen lds
    s_add_u32 m0, s65, 2048
    s_add_u32 s58, s58, 0x4000
    buffer_load_dwordx4 v96, s[4:7], s58 offen lds
    s_add_u32 m0, s65, 3072
    s_nop 0
    buffer_load_dwordx4 v97, s[4:7], s58 offen lds
    s_add_u32 s58, s69, 1
    s_and_b32 s58, s58, 7
    s_mul_i32 s58, s58, 0x30000
    s_add_u32 m0, s64, 73728
    s_add_u32 s58, s58, s57
    buffer_load_dwordx4 v98, s[8:11], s58 offen lds
    s_add_u32 m0, s64, 74752
    s_add_u32 s58, s58, 0x6000
    buffer_load_dwordx4 v98, s[8:11], s58 offen lds
    s_lshr_b32 s58, s49, 1
    s_lshl1_add_u32 s58, s2, s58
    s_mul_i32 s58, s58, 3072
    s_and_b32 s59, s49, 1
    s_lshl_b32 s59, s59, 9
    s_add_u32 s58, s58, s59
    v_lshlrev_b32 v6, 7, v1
    s_mov_b64 exec, 15
    buffer_load_dword v9, v6, s[8:11], s58 offen
    s_mov_b64 exec, -1
    s_load_dwordx2 s[28:29], s[0:1], 16
    s_load_dwordx8 s[32:39], s[0:1], 32
    s_load_dwordx2 s[16:17], s[0:1], 64
    s_mov_b32 s18, 0x200000
    s_mov_b32 s19, 0x20000
    s_mov_b32 s3, 0x3f803f80
    s_mov_b32 s67, 0
    v_lshrrev_b32 v6, 2, v1
    v_mul_u32_u24 v6, 0xc00, v6
    v_and_b32 v7, 3, v1
    v_lshl_add_u32 v99, v7, 4, v6
    v_mov_b32 v6, 106496
    v_mov_b32 v7, 0
    ds_write_b32 v6, v7
    ds_write2_b32 v6, v7, v7 offset0:8 offset1:9
    ds_write2_b32 v6, v7, v7 offset0:10 offset1:11
    s_waitcnt lgkmcnt(0)
    s_getreg_b32 s31, hwreg(HW_REG_XCC_ID, 0, 4)
    s_mul_i32 s46, s46, 0x9e3779b1
    s_add_u32 s46, s46, 0x7f4a7c15
    s_add_u32 s47, s47, 0x632be5ab
    s_xor_b32 s31, s31, s47
    v_mov_b32 v22, s46
    s_lshl_b32 s60, s51, 12
    s_add_u32 s60, s60, 262144
    s_lshl_b32 s61, s49, 10
    s_add_u32 s60, s60, s61
    v_and_b32 v61, 7, v1
    v_lshl_add_u32 v61, v61, 7, s60
    v_mov_b32 v23, s47
    s_lshr_b32 s60, s54, 1
    s_lshl3_add_u32 s60, s51, s60
    s_lshl2_add_u32 s60, s60, s49
    s_lshl_b32 s60, s60, 5
    s_add_u32 s60, s60, 8192
    v_and_b32 v62, 3, v1
    v_lshl_add_u32 v62, v62, 3, s60
    v_bfe_u32 v6, v1, 2, 2
    v_lshrrev_b32 v7, 5, v1
    v_lshl_add_u32 v6, v7, 3, v6
    v_lshrrev_b32 v7, 2, v1
    v_and_b32 v7, 4, v7
    v_and_or_b32 v7, v1, 3, v7
    v_lshlrev_b32 v7, 3, v7
    v_lshl_add_u32 v6, v6, 6, v7
    s_lshl_b32 s58, s49, 13
    s_add_u32 s58, s58, 131072
    v_add_u32 v100, s58, v6
    v_mov_b32 v102, 0
    s_lshl_b32 s58, s49, 2
    s_add_u32 s58, s58, 110592
    v_lshl_add_u32 v101, v1, 4, s58
    v_mov_b32 v64, 0
    v_mov_b32 v65, 0
    v_mov_b32 v66, 0
    v_mov_b32 v67, 0
    s_nop 1
    v_mfma_f32_32x32x16_bf16 v[128:143], v[64:67], v[64:67], 0
    v_mfma_f32_32x32x16_bf16 v[144:159], v[64:67], v[64:67], 0
    v_mfma_f32_32x32x16_bf16 v[160:175], v[64:67], v[64:67], 0
    v_mfma_f32_32x32x16_bf16 v[176:191], v[64:67], v[64:67], 0
    s_add_u32 s58, s69, 1
    s_and_b32 s58, s58, 7
    s_lshl_b32 s58, s58, 7
    s_add_u32 m0, s65, 16384
    s_add_u32 s58, s58, s56
    buffer_load_dwordx4 v96, s[4:7], s58 offen lds
    s_add_u32 m0, s65, 17408
    s_nop 0
    buffer_load_dwordx4 v97, s[4:7], s58 offen lds
    s_add_u32 m0, s65, 18432
    s_add_u32 s58, s58, 0x4000
    buffer_load_dwordx4 v96, s[4:7], s58 offen lds
    s_add_u32 m0, s65, 19456
    s_nop 0
    buffer_load_dwordx4 v97, s[4:7], s58 offen lds
    s_add_u32 s58, s69, 2
    s_and_b32 s58, s58, 7
    s_mul_i32 s58, s58, 0x30000
    s_add_u32 m0, s64, 81920
    s_add_u32 s58, s58, s57
    buffer_load_dwordx4 v98, s[8:11], s58 offen lds
    s_add_u32 m0, s64, 82944
    s_add_u32 s58, s58, 0x6000
    buffer_load_dwordx4 v98, s[8:11], s58 offen lds
    s_lshl2_add_u32 s58, s52, s49
    s_mul_i32 s58, s58, 12288
    v_mul_u32_u24 v6, 0xc00, v1
    s_mov_b64 exec, 15
    buffer_load_dword v9, v6, s[8:11], s58 offen offset:384
    s_mov_b64 exec, -1
    s_waitcnt vmcnt(10)
    s_barrier
    s_add_u32 s58, s69, 2
    s_and_b32 s58, s58, 7
    s_lshl_b32 s58, s58, 7
    s_add_u32 m0, s65, 32768
    s_add_u32 s58, s58, s56
    buffer_load_dwordx4 v96, s[4:7], s58 offen lds
    s_add_u32 m0, s65, 33792
    s_nop 0
    buffer_load_dwordx4 v97, s[4:7], s58 offen lds
    s_add_u32 m0, s65, 34816
    s_add_u32 s58, s58, 0x4000
    buffer_load_dwordx4 v96, s[4:7], s58 offen lds
    s_add_u32 m0, s65, 35840
    s_nop 0
    buffer_load_dwordx4 v97, s[4:7], s58 offen lds
    s_add_u32 s58, s69, 3
    s_and_b32 s58, s58, 7
    s_mul_i32 s58, s58, 0x30000
    s_add_u32 m0, s64, 90112
    s_add_u32 s58, s58, s57
    buffer_load_dwordx4 v98, s[8:11], s58 offen lds
    s_add_u32 m0, s64, 91136
    s_add_u32 s58, s58, 0x6000
    buffer_load_dwordx4 v98, s[8:11], s58 offen lds
    s_waitcnt vmcnt(9)
    s_barrier
    s_add_u32 s58, s69, 3
    s_and_b32 s58, s58, 7
    s_lshl_b32 s58, s58, 7
    s_add_u32 m0, s65, 49152
    s_add_u32 s58, s58, s56
    buffer_load_dwordx4 v96, s[4:7], s58 offen lds
    s_add_u32 m0, s65, 50176
    s_nop 0
    buffer_load_dwordx4 v97, s[4:7], s58 offen lds
    s_add_u32 m0, s65, 51200
    s_add_u32 s58, s58, 0x4000
    buffer_load_dwordx4 v96, s[4:7], s58 offen lds
    s_add_u32 m0, s65, 52224
    s_nop 0
    buffer_load_dwordx4 v97, s[4:7], s58 offen lds
    s_add_u32 s58, s69, 4
    s_and_b32 s58, s58, 7
    s_mul_i32 s58, s58, 0x30000
    s_add_u32 m0, s64, 65536
    s_add_u32 s58, s58, s57
    buffer_load_dwordx4 v98, s[8:11], s58 offen lds
    s_add_u32 m0, s64, 66560
    s_add_u32 s58, s58, 0x6000
    buffer_load_dwordx4 v98, s[8:11], s58 offen lds
    s_add_u32 s58, s69, 4
    s_and_b32 s58, s58, 7
    s_lshl_b32 s58, s58, 7
    s_add_u32 m0, s65, 0
    s_add_u32 s58, s58, s56
    buffer_load_dwordx4 v96, s[4:7], s58 offen lds
    s_add_u32 m0, s65, 1024
    s_nop 0
    buffer_load_dwordx4 v97, s[4:7], s58 offen lds
    s_add_u32 m0, s65, 2048
    s_add_u32 s58, s58, 0x4000
    buffer_load_dwordx4 v96, s[4:7], s58 offen lds
    s_add_u32 m0, s65, 3072
    s_nop 0
    buffer_load_dwordx4 v97, s[4:7], s58 offen lds
    s_waitcnt vmcnt(12)
    s_barrier
    s_add_u32 s58, s69, 5
    s_and_b32 s58, s58, 7
    s_mul_i32 s58, s58, 0x30000
    s_add_u32 m0, s64, 73728
    s_add_u32 s58, s58, s57
    buffer_load_dwordx4 v98, s[8:11], s58 offen lds
    s_add_u32 m0, s64, 74752
    s_add_u32 s58, s58, 0x6000
    buffer_load_dwordx4 v98, s[8:11], s58 offen lds
    s_add_u32 s58, s69, 5
    s_and_b32 s58, s58, 7
    s_lshl_b32 s58, s58, 7
    s_add_u32 m0, s65, 16384
    s_add_u32 s58, s58, s56
    buffer_load_dwordx4 v96, s[4:7], s58 offen lds
    s_add_u32 m0, s65, 17408
    s_nop 0
    buffer_load_dwordx4 v97, s[4:7], s58 offen lds
    s_add_u32 m0, s65, 18432
    s_add_u32 s58, s58, 0x4000
    buffer_load_dwordx4 v96, s[4:7], s58 offen lds
    s_add_u32 m0, s65, 19456
    s_nop 0
    buffer_load_dwordx4 v97, s[4:7], s58 offen lds
    s_waitcnt vmcnt(12)
    s_barrier
    s_add_u32 s58, s69, 6
    s_and_b32 s58, s58, 7
    s_mul_i32 s58, s58, 0x30000
    s_add_u32 m0, s64, 81920
    s_add_u32 s58, s58, s57
    buffer_load_dwordx4 v98, s[8:11], s58 offen lds
    s_add_u32 m0, s64, 82944
    s_add_u32 s58, s58, 0x6000
    buffer_load_dwordx4 v98, s[8:11], s58 offen lds
    s_add_u32 s58, s69, 6
    s_and_b32 s58, s58, 7
    s_lshl_b32 s58, s58, 7
    s_add_u32 m0, s65, 32768
    s_add_u32 s58, s58, s56
    buffer_load_dwordx4 v96, s[4:7], s58 offen lds
    s_add_u32 m0, s65, 33792
    s_nop 0
    buffer_load_dwordx4 v97, s[4:7], s58 offen lds
    s_add_u32 m0, s65, 34816
    s_add_u32 s58, s58, 0x4000
    buffer_load_dwordx4 v96, s[4:7], s58 offen lds
    s_add_u32 m0, s65, 35840
    s_nop 0
    buffer_load_dwordx4 v97, s[4:7], s58 offen lds
    s_waitcnt vmcnt(12)
    s_barrier
    s_add_u32 s58, s69, 7
    s_and_b32 s58, s58, 7
    s_mul_i32 s58, s58, 0x30000
    s_add_u32 m0, s64, 90112
    s_add_u32 s58, s58, s57
    buffer_load_dwordx4 v98, s[8:11], s58 offen lds
    s_add_u32 m0, s64, 91136
    s_add_u32 s58, s58, 0x6000
    buffer_load_dwordx4 v98, s[8:11], s58 offen lds
    s_add_u32 s58, s69, 7
    s_and_b32 s58, s58, 7
    s_lshl_b32 s58, s58, 7
    s_add_u32 m0, s65, 49152
    s_add_u32 s58, s58, s56
    buffer_load_dwordx4 v96, s[4:7], s58 offen lds
    s_add_u32 m0, s65, 50176
    s_nop 0
    buffer_load_dwordx4 v97, s[4:7], s58 offen lds
    s_add_u32 m0, s65, 51200
    s_add_u32 s58, s58, 0x4000
    buffer_load_dwordx4 v96, s[4:7], s58 offen lds
    s_add_u32 m0, s65, 52224
    s_nop 0
    buffer_load_dwordx4 v97, s[4:7], s58 offen lds
    s_waitcnt vmcnt(12)
    s_barrier
    buffer_load_dwordx2 v[8:9], v62, s[12:15], 0 offen sc1
    buffer_load_dwordx2 v[8:9], v61, s[12:15], 0 offen sc1
    s_lshl1_add_u32 s58, s49, s69
    s_add_u32 s58, s58, 0
    s_and_b32 s58, s58, 7
    s_mul_i32 s58, s58, 0x30000
    s_lshl_b32 s59, s54, 6
    s_add_u32 s58, s58, s59
    s_lshl_b32 s59, s49, 13
    s_add_u32 m0, s59, 131072
    s_add_u32 s60, s58, 0
    buffer_load_dwordx4 v99, s[8:11], s60 offen lds
    s_add_u32 m0, s59, 132096
    s_add_u32 s60, s58, 49152
    buffer_load_dwordx4 v99, s[8:11], s60 offen lds
    s_add_u32 m0, s59, 133120
    s_add_u32 s60, s58, 98304
    buffer_load_dwordx4 v99, s[8:11], s60 offen lds
    s_waitcnt vmcnt(11)
    s_barrier
    s_lshl1_add_u32 s58, s49, s69
    s_add_u32 s58, s58, 0
    s_and_b32 s58, s58, 7
    s_mul_i32 s58, s58, 0x30000
    s_lshl_b32 s59, s54, 6
    s_add_u32 s58, s58, s59
    s_lshl_b32 s59, s49, 13
    s_add_u32 m0, s59, 134144
    s_add_u32 s60, s58, 147456
    buffer_load_dwordx4 v99, s[8:11], s60 offen lds
    s_lshl1_add_u32 s58, s49, s69
    s_add_u32 s58, s58, 1
    s_and_b32 s58, s58, 7
    s_mul_i32 s58, s58, 0x30000
    s_lshl_b32 s59, s54, 6
    s_add_u32 s58, s58, s59
    s_lshl_b32 s59, s49, 13
    s_add_u32 m0, s59, 135168
    s_add_u32 s60, s58, 0
    buffer_load_dwordx4 v99, s[8:11], s60 offen lds
    s_add_u32 m0, s59, 136192
    s_add_u32 s60, s58, 49152
    buffer_load_dwordx4 v99, s[8:11], s60 offen lds
    s_waitcnt vmcnt(8)
    s_barrier
    s_lshl1_add_u32 s58, s49, s69
    s_add_u32 s58, s58, 1
    s_and_b32 s58, s58, 7
    s_mul_i32 s58, s58, 0x30000
    s_lshl_b32 s59, s54, 6
    s_add_u32 s58, s58, s59
    s_lshl_b32 s59, s49, 13
    s_add_u32 m0, s59, 137216
    s_add_u32 s60, s58, 98304
    buffer_load_dwordx4 v99, s[8:11], s60 offen lds
    s_add_u32 m0, s59, 138240
    s_add_u32 s60, s58, 147456
    buffer_load_dwordx4 v99, s[8:11], s60 offen lds
    s_waitcnt vmcnt(8)
    v_xor_b32 v104, s46, v8
    v_xor_b32 v105, s47, v9
    v_lshrrev_b32 v105, 4, v105
    v_or_b32 v104, v104, v105
    v_cmp_ne_u32 vcc, 0, v104
    s_cbranch_vccnz Lpu_1
Lpr_2:
    v_cmp_eq_u32 vcc, s31, v9
    s_nop 0
    s_cmp_eq_u64 vcc, -1
    s_cselect_b32 s30, 1, 0
    s_lshl2_add_u32 s58, s49, 106512
    v_mov_b32 v104, s58
    v_mov_b32 v105, s30
    ds_write_b32 v104, v105
    s_waitcnt lgkmcnt(0)
    s_barrier
    v_mov_b32 v2, 0xdddd
    v_lshlrev_b32 v3, 4, v1
    v_and_b32 v10, 15, v1
    v_lshrrev_b32 v11, 5, v1
    v_lshl_add_u32 v11, v11, 4, v10
    v_lshlrev_b32 v4, 4, v11
    s_lshl_b32 s84, s51, 1
    s_lshr_b32 s58, s54, 1
    s_lshl2_add_u32 s58, s58, s49
    s_lshl_b32 s58, s58, 12
    s_add_u32 s100, s58, 327680
    s_lshl1_add_u32 s58, s54, s50
    s_lshl_b32 s58, s58, 17
    s_lshl_b32 s59, s49, 11
    s_add_u32 s58, s58, s59
    s_add_u32 s68, s58, 2097152
    s_mov_b32 s40, 0xffff
    s_mov_b32 s41, 0xffff
    s_mov_b32 s66, 0
    v_and_b32 v10, 27, v1
    v_cmp_eq_u32 vcc, 16, v10
    v_mov_b32 v11, s3
    s_nop 0
    v_cndmask_b32 v10, 0, v11, vcc
    v_mov_b32 v28, v10
    v_mov_b32 v29, v10
    v_mov_b32 v30, v10
    v_mov_b32 v31, v10
    v_mov_b32 v32, v10
    v_mov_b32 v33, v10
    v_mov_b32 v34, v10
    v_mov_b32 v35, v10
    v_mov_b32 v40, v10
    v_mov_b32 v41, v10
    v_mov_b32 v42, v10
    v_mov_b32 v43, v10
    v_mov_b32 v44, v10
    v_mov_b32 v45, v10
    v_mov_b32 v46, v10
    v_mov_b32 v47, v10
    v_mov_b32 v52, v10
    v_mov_b32 v53, v10
    v_mov_b32 v54, v10
    v_mov_b32 v55, v10
    v_mov_b32 v56, v10
    v_mov_b32 v57, v10
    v_mov_b32 v58, v10
    v_mov_b32 v59, v10
    v_mov_b32 v104, 106512
    ds_read_b128 v[104:107], v104
    s_lshl_b32 s59, s50, 12
    s_add_u32 s59, s59, 98304
    s_add_u32 s58, s49, 1
    s_and_b32 s58, s58, 3
    s_lshl_b32 s58, s58, 10
    s_add_u32 s58, s58, s59
    v_add_u32 v124, s58, v3
    s_add_u32 s58, s49, 2
    s_and_b32 s58, s58, 3
    s_lshl_b32 s58, s58, 10
    s_add_u32 s58, s58, s59
    v_add_u32 v125, s58, v3
    s_add_u32 s58, s49, 3
    s_and_b32 s58, s58, 3
    s_lshl_b32 s58, s58, 10
    s_add_u32 s58, s58, s59
    v_add_u32 v126, s58, v3
    s_add_u32 s58, s49, 4
    s_and_b32 s58, s58, 3
    s_lshl_b32 s58, s58, 10
    s_add_u32 s58, s58, s59
    v_add_u32 v127, s58, v3
    s_waitcnt vmcnt(0)
    ds_read_b64_tr_b16 v[64:65], v100 offset:0
    ds_read_b64_tr_b16 v[66:67], v100 offset:256
    ds_read_b64_tr_b16 v[68:69], v100 offset:1024
    ds_read_b64_tr_b16 v[70:71], v100 offset:1280
    ds_read_b64_tr_b16 v[72:73], v100 offset:2048
    ds_read_b64_tr_b16 v[74:75], v100 offset:2304
    ds_read_b64_tr_b16 v[76:77], v100 offset:3072
    ds_read_b64_tr_b16 v[78:79], v100 offset:3328
    ds_read_b64_tr_b16 v[80:81], v100 offset:4096
    ds_read_b64_tr_b16 v[82:83], v100 offset:4352
    ds_read_b64_tr_b16 v[84:85], v100 offset:5120
    ds_read_b64_tr_b16 v[86:87], v100 offset:5376
    ds_read_b64_tr_b16 v[88:89], v100 offset:6144
    ds_read_b64_tr_b16 v[90:91], v100 offset:6400
    ds_read_b64_tr_b16 v[92:93], v100 offset:7168
    ds_read_b64_tr_b16 v[94:95], v100 offset:7424
    s_waitcnt lgkmcnt(0)
    v_dot2c_f32_bf16 v102, s3, v64
    v_dot2c_f32_bf16 v102, s3, v65
    v_dot2c_f32_bf16 v102, s3, v66
    v_dot2c_f32_bf16 v102, s3, v67
    v_dot2c_f32_bf16 v102, s3, v68
    v_dot2c_f32_bf16 v102, s3, v69
    v_dot2c_f32_bf16 v102, s3, v70
    v_dot2c_f32_bf16 v102, s3, v71
    v_dot2c_f32_bf16 v102, s3, v72
    v_dot2c_f32_bf16 v102, s3, v73
    v_dot2c_f32_bf16 v102, s3, v74
    v_dot2c_f32_bf16 v102, s3, v75
    v_dot2c_f32_bf16 v102, s3, v76
    v_dot2c_f32_bf16 v102, s3, v77
    v_dot2c_f32_bf16 v102, s3, v78
    v_dot2c_f32_bf16 v102, s3, v79
    v_dot2c_f32_bf16 v102, s3, v80
    v_dot2c_f32_bf16 v102, s3, v81
    v_dot2c_f32_bf16 v102, s3, v82
    v_dot2c_f32_bf16 v102, s3, v83
    v_dot2c_f32_bf16 v102, s3, v84
    v_dot2c_f32_bf16 v102, s3, v85
    v_dot2c_f32_bf16 v102, s3, v86
    v_dot2c_f32_bf16 v102, s3, v87
    v_dot2c_f32_bf16 v102, s3, v88
    v_dot2c_f32_bf16 v102, s3, v89
    v_dot2c_f32_bf16 v102, s3, v90
    v_dot2c_f32_bf16 v102, s3, v91
    v_dot2c_f32_bf16 v102, s3, v92
    v_dot2c_f32_bf16 v102, s3, v93
    v_dot2c_f32_bf16 v102, s3, v94
    v_dot2c_f32_bf16 v102, s3, v95
    s_nop 2
    v_cvt_pk_bf16_f32 v103, v102, v102
    v_and_b32 v103, 0xffff0000, v103
    v_sub_f32 v102, v102, v103
    v_cvt_pk_bf16_f32 v102, v103, v102
    ds_write_b32 v101, v102
    v_and_b32 v104, v104, v105
    v_and_b32 v106, v106, v107
    v_and_b32 v104, v104, v106
    s_nop 0
    v_readfirstlane_b32 s30, v104
    s_waitcnt lgkmcnt(0)
    s_barrier
    s_branch L_f1_tail
L_f0:
    s_lshl2_add_u32 s58, s53, s49
    s_lshl_b32 s58, s58, 9
    s_add_u32 s58, s58, 458752
    v_add_u32 v29, s58, v72
    s_lshl_b32 s58, s49, 5
    s_add_u32 s58, s58, 106560
    v_lshl_add_u32 v75, v73, 4, s58
    s_lshl_b32 s65, s65, 7
    s_add_u32 s65, s65, 458752
    s_cmp_eq_u32 s49, 2
    s_cselect_b32 s65, s65, 1073741824
    v_lshl_add_u32 v30, v1, 4, s65
    s_load_dwordx2 s[46:47], s[12:13], 0
    s_load_dwordx2 s[28:29], s[0:1], 16
    s_load_dwordx8 s[32:39], s[0:1], 32
    s_load_dwordx2 s[16:17], s[0:1], 64
    s_mov_b32 s18, 0x200000
    s_mov_b32 s19, 0x20000
    s_mov_b32 s3, 0x3f803f80
    s_mov_b32 s67, 0
    v_and_b32 v32, 31, v1
    v_lshrrev_b32 v33, 5, v1
    v_bfe_u32 v34, v32, 1, 3
    v_xor_b32 v34, v34, v33
    s_lshl_b32 s59, s49, 1
    v_xor_b32 v34, s59, v34
    v_lshlrev_b32 v34, 4, v34
    s_lshl_b32 s59, s49, 12
    v_lshl_add_u32 v35, v32, 7, s59
    v_add_u32 v5, v34, v35
    v_xor_b32 v6, 32, v5
    v_xor_b32 v7, 64, v5
    v_xor_b32 v8, 96, v5
    v_bfe_u32 v34, v1, 2, 2
    v_lshrrev_b32 v35, 5, v1
    v_lshl_add_u32 v34, v35, 3, v34
    v_lshrrev_b32 v35, 2, v1
    v_and_b32 v35, 4, v35
    v_and_or_b32 v35, v1, 3, v35
    v_lshlrev_b32 v35, 3, v35
    v_bfe_u32 v36, v1, 3, 1
    v_lshl_add_u32 v36, v36, 6, v35
    v_lshl_add_u32 v36, v34, 7, v36
    s_lshl_b32 s59, s49, 11
    s_add_u32 s59, s59, 65536
    v_add_u32 v9, s59, v36
    v_xor_b32 v10, 2048, v9
    v_xor_b32 v11, 4096, v9
    v_xor_b32 v12, 6144, v9
    v_xor_b32 v24, 64, v9
    v_xor_b32 v25, 64, v10
    v_xor_b32 v26, 64, v11
    v_xor_b32 v27, 64, v12
    v_lshl_add_u32 v36, v34, 6, v35
    s_lshl_b32 s59, s49, 10
    s_add_u32 s59, s59, 131072
    v_add_u32 v13, s59, v36
    v_xor_b32 v14, 1024, v13
    v_xor_b32 v15, 2048, v13
    v_xor_b32 v16, 3072, v13
    v_mov_b32 v17, 0
    v_mov_b32 v28, 0
    v_mov_b32 v18, 0
    v_mov_b32 v19, 0
    s_lshl_b32 s58, s49, 2
    s_add_u32 s58, s58, 108544
    v_lshl_add_u32 v31, v1, 4, s58
    s_waitcnt lgkmcnt(0)
    s_cmp_lg_u32 s49, 1
    s_cbranch_scc1 Ltlb_3
    s_lshl_b32 s58, s52, 7
    s_min_u32 s59, s58, 2624
    s_and_b32 s58, s58, 0x380
    v_mov_b32 v40, s58
    v_mov_b32 v41, s59
    s_mov_b64 exec, 1
    global_load_dword v3, v41, s[34:35]
    global_load_dword v3, v40, s[38:39]
    s_mov_b64 exec, -1
Ltlb_3:
    s_getreg_b32 s31, hwreg(HW_REG_XCC_ID, 0, 4)
    s_mul_i32 s46, s46, 0x9e3779b1
    s_add_u32 s46, s46, 0x7f4a7c15
    s_add_u32 s47, s47, 0x632be5ab
    s_xor_b32 s31, s31, s47
    v_mov_b32 v22, s46
    s_lshl_b32 s60, s51, 12
    s_add_u32 s60, s60, 262144
    v_mov_b32 v23, s31
    s_lshl_b32 s61, s52, 7
    s_add_u32 s61, s61, s60
    s_cmp_eq_u32 s49, 0
    s_cselect_b32 s61, s61, 1073741824
    v_mov_b32 v61, s61
    s_mov_b64 exec, 1
    buffer_store_dwordx2 v[22:23], v61, s[12:15], 0 offen sc1
    s_mov_b64 exec, -1
    s_nop 1
    v_mov_b32 v23, s47
    s_lshr_b32 s58, s54, 1
    s_lshl2_add_u32 s59, s53, s49
    s_lshl_b32 s60, s58, 19
    s_lshl_b32 s59, s59, 11
    s_add_u32 s60, s60, s59
    s_add_u32 s60, s60, 2097152
    s_lshl2_add_u32 s58, s58, s49
    s_and_b32 s61, s54, 1
    s_lshl1_add_u32 s59, s58, s61
    s_lshl4_add_u32 s59, s59, s53
    s_lshl_b32 s59, s59, 7
    s_add_u32 s64, s59, 327680
    s_lshl_b32 s59, s51, 5
    s_add_u32 s58, s58, s59
    s_and_b32 s59, s52, 1
    s_lshl1_add_u32 s58, s58, s59
    s_lshl1_add_u32 s58, s58, s61
    s_lshl3_add_u32 s63, s58, 8192
    s_bitcmp1_b32 s54, 0
    s_cbranch_scc1 L_typeV
    s_waitcnt lgkmcnt(0)
    s_barrier
    ds_read_b128 v[128:131], v5 offset:0
    ds_read_b64_tr_b16 v[32:33], v9 offset:0
    ds_read_b64_tr_b16 v[34:35], v9 offset:512
    ds_read_b64_tr_b16 v[36:37], v24 offset:0
    ds_read_b64_tr_b16 v[38:39], v24 offset:512
    ds_read_b128 v[132:135], v6 offset:0
    ds_read_b64_tr_b16 v[40:41], v10 offset:0
    ds_read_b64_tr_b16 v[42:43], v10 offset:512
    ds_read_b64_tr_b16 v[44:45], v25 offset:0
    ds_read_b64_tr_b16 v[46:47], v25 offset:512
    s_waitcnt vmcnt(1)
    v_dot2c_f32_bf16 v18, s3, v64
    v_dot2c_f32_bf16 v19, v64, v64
    v_dot2c_f32_bf16 v18, s3, v65
    v_dot2c_f32_bf16 v19, v65, v65
    v_dot2c_f32_bf16 v18, s3, v66
    v_dot2c_f32_bf16 v19, v66, v66
    v_dot2c_f32_bf16 v18, s3, v67
    v_dot2c_f32_bf16 v19, v67, v67
    v_dot2c_f32_bf16 v18, s3, v68
    v_dot2c_f32_bf16 v19, v68, v68
    v_dot2c_f32_bf16 v18, s3, v69
    v_dot2c_f32_bf16 v19, v69, v69
    v_dot2c_f32_bf16 v18, s3, v70
    v_dot2c_f32_bf16 v19, v70, v70
    v_dot2c_f32_bf16 v18, s3, v71
    v_dot2c_f32_bf16 v19, v71, v71
    s_waitcnt lgkmcnt(7)
    v_mfma_f32_32x32x16_bf16 v[96:111], v[32:35], v[128:131], 0
    ds_read_b128 v[136:139], v7 offset:0
    ds_read_b64_tr_b16 v[48:49], v11 offset:0
    ds_read_b64_tr_b16 v[50:51], v11 offset:512
    v_add_f32_dpp v18, v18, v18 row_ror:8 row_mask:0xf bank_mask:0xf
    v_add_f32_dpp v19, v19, v19 row_ror:8 row_mask:0xf bank_mask:0xf
    s_nop 0
    v_add_f32_dpp v18, v18, v18 row_ror:4 row_mask:0xf bank_mask:0xf
    s_waitcnt lgkmcnt(8)
    v_mfma_f32_32x32x16_bf16 v[112:127], v[36:39], v[128:131], 0
    ds_read_b64_tr_b16 v[52:53], v26 offset:0
    ds_read_b64_tr_b16 v[54:55], v26 offset:512
    v_add_f32_dpp v19, v19, v19 row_ror:4 row_mask:0xf bank_mask:0xf
    v_add_f32_dpp v18, v18, v18 row_ror:2 row_mask:0xf bank_mask:0xf
    s_nop 0
    v_add_f32_dpp v19, v19, v19 row_ror:2 row_mask:0xf bank_mask:0xf
    s_waitcnt lgkmcnt(7)
    v_mfma_f32_32x32x16_bf16 v[96:111], v[40:43], v[132:135], v[96:111]
    ds_read_b128 v[140:143], v8 offset:0
    ds_read_b64_tr_b16 v[56:57], v12 offset:0
    ds_read_b64_tr_b16 v[58:59], v12 offset:512
    v_add_f32_dpp v18, v18, v18 row_ror:1 row_mask:0xf bank_mask:0xf
    v_add_f32_dpp v19, v19, v19 row_ror:1 row_mask:0xf bank_mask:0xf
    v_mov_b32 v64, v18
    s_waitcnt lgkmcnt(8)
    v_mfma_f32_32x32x16_bf16 v[112:127], v[44:47], v[132:135], v[112:127]
    ds_read_b64_tr_b16 v[60:61], v27 offset:0
    ds_read_b64_tr_b16 v[62:63], v27 offset:512
    v_mov_b32 v65, v19
    v_permlane16_swap_b32 v64, v18
    s_nop 0
    v_permlane16_swap_b32 v65, v19
    s_waitcnt lgkmcnt(7)
    v_mfma_f32_32x32x16_bf16 v[96:111], v[48:51], v[136:139], v[96:111]
    v_add_f32 v18, v64, v18
    v_add_f32 v19, v65, v19
    v_mul_f32 v18, 0x3b000000, v18
    v_cvt_pk_bf16_f32 v70, -v18, -v18
    v_mul_f32 v19, 0x3b000000, v19
    v_fma_f32 v19, -v18, v18, v19
    s_waitcnt lgkmcnt(5)
    v_mfma_f32_32x32x16_bf16 v[112:127], v[52:55], v[136:139], v[112:127]
    v_max_f32 v19, 0, v19
    v_cvt_pk_bf16_f32 v19, v19, v19
    v_and_b32 v19, 0xffff0000, v19
    v_add_f32 v19, 0x3727c5ac, v19
    v_cvt_pk_bf16_f32 v19, v19, v19
    v_and_b32 v19, 0xffff0000, v19
    s_waitcnt lgkmcnt(2)
    v_mfma_f32_32x32x16_bf16 v[96:111], v[56:59], v[140:143], v[96:111]
    v_sqrt_f32 v19, v19
    s_nop 0
    v_cvt_pk_bf16_f32 v64, v19, v19
    v_and_b32 v64, 0xffff0000, v64
    v_rcp_f32 v71, v64
    v_mov_b32 v68, v22
    v_mov_b32 v69, v23
    s_waitcnt lgkmcnt(0)
    v_mfma_f32_32x32x16_bf16 v[112:127], v[60:63], v[140:143], v[112:127]
    v_lshlrev_b32 v2, 4, v1
    v_add_u32 v2, 106560, v2
    s_mov_b32 exec_lo, 1
    s_mov_b32 exec_hi, 1
    ds_write_b128 v75, v[68:71]
    s_mov_b64 exec, -1
    v_dot2c_f32_bf16 v17, s3, v32
    v_dot2c_f32_bf16 v28, s3, v36
    v_dot2c_f32_bf16 v17, s3, v33
    v_dot2c_f32_bf16 v28, s3, v37
    v_dot2c_f32_bf16 v17, s3, v34
    v_dot2c_f32_bf16 v28, s3, v38
    v_dot2c_f32_bf16 v17, s3, v35
    v_dot2c_f32_bf16 v28, s3, v39
    s_waitcnt lgkmcnt(0)
    s_barrier
    ds_read_b128 v[144:147], v5 offset:16384
    ds_read_b64_tr_b16 v[64:65], v9 offset:8192
    ds_read_b64_tr_b16 v[66:67], v9 offset:8704
    ds_read_b64_tr_b16 v[68:69], v24 offset:8192
    ds_read_b64_tr_b16 v[70:71], v24 offset:8704
    ds_read_b128 v[148:151], v6 offset:16384
    ds_read_b64_tr_b16 v[72:73], v10 offset:8192
    ds_read_b64_tr_b16 v[74:75], v10 offset:8704
    ds_read_b64_tr_b16 v[76:77], v25 offset:8192
    ds_read_b64_tr_b16 v[78:79], v25 offset:8704
    ds_read_b128 v[18:21], v2
    s_waitcnt lgkmcnt(8)
    v_mfma_f32_32x32x16_bf16 v[96:111], v[64:67], v[144:147], v[96:111]
    ds_read_b128 v[152:155], v7 offset:16384
    ds_read_b64_tr_b16 v[80:81], v11 offset:8192
    ds_read_b64_tr_b16 v[82:83], v11 offset:8704
    s_waitcnt lgkmcnt(9)
    v_mfma_f32_32x32x16_bf16 v[112:127], v[68:71], v[144:147], v[112:127]
    ds_read_b64_tr_b16 v[84:85], v26 offset:8192
    ds_read_b64_tr_b16 v[86:87], v26 offset:8704
    s_waitcnt lgkmcnt(8)
    v_mfma_f32_32x32x16_bf16 v[96:111], v[72:75], v[148:151], v[96:111]
    ds_read_b128 v[156:159], v8 offset:16384
    ds_read_b64_tr_b16 v[88:89], v12 offset:8192
    ds_read_b64_tr_b16 v[90:91], v12 offset:8704
    s_waitcnt lgkmcnt(9)
    v_mfma_f32_32x32x16_bf16 v[112:127], v[76:79], v[148:151], v[112:127]
    ds_read_b64_tr_b16 v[92:93], v27 offset:8192
    ds_read_b64_tr_b16 v[94:95], v27 offset:8704
    s_waitcnt lgkmcnt(7)
    v_mfma_f32_32x32x16_bf16 v[96:111], v[80:83], v[152:155], v[96:111]
    s_waitcnt lgkmcnt(10)
    s_mov_b64 exec, 0xff
    buffer_store_dwordx4 v[18:21], v30, s[12:15], 0 offen sc1
    s_mov_b64 exec, -1
    s_waitcnt lgkmcnt(5)
    v_mfma_f32_32x32x16_bf16 v[112:127], v[84:87], v[152:155], v[112:127]
    s_waitcnt lgkmcnt(2)
    v_mfma_f32_32x32x16_bf16 v[96:111], v[88:91], v[156:159], v[96:111]
    s_waitcnt lgkmcnt(0)
    v_mfma_f32_32x32x16_bf16 v[112:127], v[92:95], v[156:159], v[112:127]
    v_dot2c_f32_bf16 v17, s3, v64
    v_dot2c_f32_bf16 v28, s3, v68
    v_dot2c_f32_bf16 v17, s3, v65
    v_dot2c_f32_bf16 v28, s3, v69
    v_dot2c_f32_bf16 v17, s3, v66
    v_dot2c_f32_bf16 v28, s3, v70
    v_dot2c_f32_bf16 v17, s3, v67
    v_dot2c_f32_bf16 v28, s3, v71
    s_waitcnt lgkmcnt(0)
    s_barrier
    ds_read_b128 v[160:163], v5 offset:32768
    ds_read_b64_tr_b16 v[32:33], v9 offset:16384
    ds_read_b64_tr_b16 v[34:35], v9 offset:16896
    ds_read_b64_tr_b16 v[36:37], v24 offset:16384
    ds_read_b64_tr_b16 v[38:39], v24 offset:16896
    ds_read_b128 v[164:167], v6 offset:32768
    ds_read_b64_tr_b16 v[40:41], v10 offset:16384
    ds_read_b64_tr_b16 v[42:43], v10 offset:16896
    ds_read_b64_tr_b16 v[44:45], v25 offset:16384
    ds_read_b64_tr_b16 v[46:47], v25 offset:16896
    ds_read_b128 v[168:171], v7 offset:32768
    ds_read_b64_tr_b16 v[48:49], v11 offset:16384
    ds_read_b64_tr_b16 v[50:51], v11 offset:16896
    ds_read_b64_tr_b16 v[52:53], v26 offset:16384
    ds_read_b64_tr_b16 v[54:55], v26 offset:16896
    s_waitcnt lgkmcnt(12)
    v_mfma_f32_32x32x16_bf16 v[96:111], v[32:35], v[160:163], v[96:111]
    ds_read_b128 v[172:175], v8 offset:32768
    ds_read_b64_tr_b16 v[56:57], v12 offset:16384
    ds_read_b64_tr_b16 v[58:59], v12 offset:16896
    s_waitcnt lgkmcnt(13)
    v_mfma_f32_32x32x16_bf16 v[112:127], v[36:39], v[160:163], v[112:127]
    ds_read_b64_tr_b16 v[60:61], v27 offset:16384
    ds_read_b64_tr_b16 v[62:63], v27 offset:16896
    s_waitcnt lgkmcnt(12)
    v_mfma_f32_32x32x16_bf16 v[96:111], v[40:43], v[164:167], v[96:111]
    s_waitcnt lgkmcnt(10)
    v_mfma_f32_32x32x16_bf16 v[112:127], v[44:47], v[164:167], v[112:127]
    s_waitcnt lgkmcnt(7)
    v_mfma_f32_32x32x16_bf16 v[96:111], v[48:51], v[168:171], v[96:111]
    s_waitcnt lgkmcnt(5)
    v_mfma_f32_32x32x16_bf16 v[112:127], v[52:55], v[168:171], v[112:127]
    s_waitcnt lgkmcnt(2)
    v_mfma_f32_32x32x16_bf16 v[96:111], v[56:59], v[172:175], v[96:111]
    s_waitcnt lgkmcnt(0)
    v_mfma_f32_32x32x16_bf16 v[112:127], v[60:63], v[172:175], v[112:127]
    v_dot2c_f32_bf16 v17, s3, v32
    v_dot2c_f32_bf16 v28, s3, v36
    v_dot2c_f32_bf16 v17, s3, v33
    v_dot2c_f32_bf16 v28, s3, v37
    v_dot2c_f32_bf16 v17, s3, v34
    v_dot2c_f32_bf16 v28, s3, v38
    v_dot2c_f32_bf16 v17, s3, v35
    v_dot2c_f32_bf16 v28, s3, v39
    s_waitcnt lgkmcnt(0)
    s_barrier
    ds_read_b128 v[176:179], v5 offset:49152
    ds_read_b64_tr_b16 v[64:65], v9 offset:24576
    ds_read_b64_tr_b16 v[66:67], v9 offset:25088
    ds_read_b64_tr_b16 v[68:69], v24 offset:24576
    ds_read_b64_tr_b16 v[70:71], v24 offset:25088
    ds_read_b128 v[180:183], v6 offset:49152
    ds_read_b64_tr_b16 v[72:73], v10 offset:24576
    ds_read_b64_tr_b16 v[74:75], v10 offset:25088
    ds_read_b64_tr_b16 v[76:77], v25 offset:24576
    ds_read_b64_tr_b16 v[78:79], v25 offset:25088
    ds_read_b128 v[184:187], v7 offset:49152
    ds_read_b64_tr_b16 v[80:81], v11 offset:24576
    ds_read_b64_tr_b16 v[82:83], v11 offset:25088
    ds_read_b64_tr_b16 v[84:85], v26 offset:24576
    ds_read_b64_tr_b16 v[86:87], v26 offset:25088
    s_waitcnt lgkmcnt(12)
    v_mfma_f32_32x32x16_bf16 v[96:111], v[64:67], v[176:179], v[96:111]
    ds_read_b128 v[188:191], v8 offset:49152
    ds_read_b64_tr_b16 v[88:89], v12 offset:24576
    ds_read_b64_tr_b16 v[90:91], v12 offset:25088
    v_lshrrev_b32 v4, 1, v1
    v_xor_b32 v4, v4, v1
    v_and_b32 v4, 4, v4
    s_waitcnt lgkmcnt(13)
    v_mfma_f32_32x32x16_bf16 v[112:127], v[68:71], v[176:179], v[112:127]
    ds_read_b64_tr_b16 v[92:93], v27 offset:24576
    ds_read_b64_tr_b16 v[94:95], v27 offset:25088
    v_mul_u32_u24 v4, 3, v4
    v_xor_b32 v4, v4, v1
    v_lshlrev_b32 v4, 4, v4
    s_waitcnt lgkmcnt(12)
    v_mfma_f32_32x32x16_bf16 v[96:111], v[72:75], v[180:183], v[96:111]
    v_lshlrev_b32 v2, 4, v1
    v_add_u32 v2, 108544, v2
    s_waitcnt lgkmcnt(10)
    v_mfma_f32_32x32x16_bf16 v[112:127], v[76:79], v[180:183], v[112:127]
    s_waitcnt lgkmcnt(7)
    v_mfma_f32_32x32x16_bf16 v[96:111], v[80:83], v[184:187], v[96:111]
    s_waitcnt lgkmcnt(5)
    v_mfma_f32_32x32x16_bf16 v[112:127], v[84:87], v[184:187], v[112:127]
    s_waitcnt lgkmcnt(2)
    v_mfma_f32_32x32x16_bf16 v[96:111], v[88:91], v[188:191], v[96:111]
    s_waitcnt lgkmcnt(0)
    v_mfma_f32_32x32x16_bf16 v[112:127], v[92:95], v[188:191], v[112:127]
    v_dot2c_f32_bf16 v17, s3, v64
    v_dot2c_f32_bf16 v28, s3, v68
    v_dot2c_f32_bf16 v17, s3, v65
    v_dot2c_f32_bf16 v28, s3, v69
    v_dot2c_f32_bf16 v17, s3, v66
    v_dot2c_f32_bf16 v28, s3, v70
    v_dot2c_f32_bf16 v17, s3, v67
    v_dot2c_f32_bf16 v28, s3, v71
    s_waitcnt lgkmcnt(0)
    s_barrier
    buffer_load_dwordx4 v[18:21], v29, s[12:15], 0 offen sc1
    ds_read_b128 v[192:195], v5 offset:0
    ds_read_b64_tr_b16 v[32:33], v9 offset:0
    ds_read_b64_tr_b16 v[34:35], v9 offset:512
    ds_read_b64_tr_b16 v[36:37], v24 offset:0
    ds_read_b64_tr_b16 v[38:39], v24 offset:512
    ds_read_b128 v[196:199], v6 offset:0
    ds_read_b64_tr_b16 v[40:41], v10 offset:0
    ds_read_b64_tr_b16 v[42:43], v10 offset:512
    ds_read_b64_tr_b16 v[44:45], v25 offset:0
    ds_read_b64_tr_b16 v[46:47], v25 offset:512
    ds_read_b128 v[200:203], v7 offset:0
    ds_read_b64_tr_b16 v[48:49], v11 offset:0
    ds_read_b64_tr_b16 v[50:51], v11 offset:512
    ds_read_b64_tr_b16 v[52:53], v26 offset:0
    ds_read_b64_tr_b16 v[54:55], v26 offset:512
    s_waitcnt lgkmcnt(12)
    v_mfma_f32_32x32x16_bf16 v[96:111], v[32:35], v[192:195], v[96:111]
    ds_read_b128 v[204:207], v8 offset:0
    ds_read_b64_tr_b16 v[56:57], v12 offset:0
    ds_read_b64_tr_b16 v[58:59], v12 offset:512
    s_waitcnt lgkmcnt(13)
    v_mfma_f32_32x32x16_bf16 v[112:127], v[36:39], v[192:195], v[112:127]
    ds_read_b64_tr_b16 v[60:61], v27 offset:0
    ds_read_b64_tr_b16 v[62:63], v27 offset:512
    s_waitcnt lgkmcnt(12)
    v_mfma_f32_32x32x16_bf16 v[96:111], v[40:43], v[196:199], v[96:111]
    s_waitcnt lgkmcnt(10)
    v_mfma_f32_32x32x16_bf16 v[112:127], v[44:47], v[196:199], v[112:127]
    s_waitcnt lgkmcnt(7)
    v_mfma_f32_32x32x16_bf16 v[96:111], v[48:51], v[200:203], v[96:111]
    s_waitcnt lgkmcnt(5)
    v_mfma_f32_32x32x16_bf16 v[112:127], v[52:55], v[200:203], v[112:127]
    s_waitcnt lgkmcnt(2)
    v_mfma_f32_32x32x16_bf16 v[96:111], v[56:59], v[204:207], v[96:111]
    s_waitcnt lgkmcnt(0)
    v_mfma_f32_32x32x16_bf16 v[112:127], v[60:63], v[204:207], v[112:127]
    v_dot2c_f32_bf16 v17, s3, v32
    v_dot2c_f32_bf16 v28, s3, v36
    v_dot2c_f32_bf16 v17, s3, v33
    v_dot2c_f32_bf16 v28, s3, v37
    v_dot2c_f32_bf16 v17, s3, v34
    v_dot2c_f32_bf16 v28, s3, v38
    v_dot2c_f32_bf16 v17, s3, v35
    v_dot2c_f32_bf16 v28, s3, v39
    s_waitcnt lgkmcnt(0)
    s_barrier
    ds_read_b128 v[208:211], v5 offset:16384
    ds_read_b64_tr_b16 v[64:65], v9 offset:8192
    ds_read_b64_tr_b16 v[66:67], v9 offset:8704
    ds_read_b64_tr_b16 v[68:69], v24 offset:8192
    ds_read_b64_tr_b16 v[70:71], v24 offset:8704
    ds_read_b128 v[212:215], v6 offset:16384
    ds_read_b64_tr_b16 v[72:73], v10 offset:8192
    ds_read_b64_tr_b16 v[74:75], v10 offset:8704
    ds_read_b64_tr_b16 v[76:77], v25 offset:8192
    ds_read_b64_tr_b16 v[78:79], v25 offset:8704
    ds_read_b128 v[216:219], v7 offset:16384
    ds_read_b64_tr_b16 v[80:81], v11 offset:8192
    ds_read_b64_tr_b16 v[82:83], v11 offset:8704
    ds_read_b64_tr_b16 v[84:85], v26 offset:8192
    ds_read_b64_tr_b16 v[86:87], v26 offset:8704
    s_waitcnt lgkmcnt(12)
    v_mfma_f32_32x32x16_bf16 v[96:111], v[64:67], v[208:211], v[96:111]
    ds_read_b128 v[220:223], v8 offset:16384
    ds_read_b64_tr_b16 v[88:89], v12 offset:8192
    ds_read_b64_tr_b16 v[90:91], v12 offset:8704
    s_waitcnt lgkmcnt(13)
    v_mfma_f32_32x32x16_bf16 v[112:127], v[68:71], v[208:211], v[112:127]
    ds_read_b64_tr_b16 v[92:93], v27 offset:8192
    ds_read_b64_tr_b16 v[94:95], v27 offset:8704
    s_waitcnt lgkmcnt(12)
    v_mfma_f32_32x32x16_bf16 v[96:111], v[72:75], v[212:215], v[96:111]
    s_waitcnt lgkmcnt(10)
    v_mfma_f32_32x32x16_bf16 v[112:127], v[76:79], v[212:215], v[112:127]
    s_waitcnt lgkmcnt(7)
    v_mfma_f32_32x32x16_bf16 v[96:111], v[80:83], v[216:219], v[96:111]
    s_waitcnt lgkmcnt(5)
    v_mfma_f32_32x32x16_bf16 v[112:127], v[84:87], v[216:219], v[112:127]
    s_waitcnt lgkmcnt(2)
    v_mfma_f32_32x32x16_bf16 v[96:111], v[88:91], v[220:223], v[96:111]
    s_waitcnt lgkmcnt(0)
    v_mfma_f32_32x32x16_bf16 v[112:127], v[92:95], v[220:223], v[112:127]
    v_dot2c_f32_bf16 v17, s3, v64
    v_dot2c_f32_bf16 v28, s3, v68
    v_dot2c_f32_bf16 v17, s3, v65
    v_dot2c_f32_bf16 v28, s3, v69
    v_dot2c_f32_bf16 v17, s3, v66
    v_dot2c_f32_bf16 v28, s3, v70
    v_dot2c_f32_bf16 v17, s3, v67
    v_dot2c_f32_bf16 v28, s3, v71
    s_waitcnt lgkmcnt(0)
    s_barrier
    ds_read_b128 v[224:227], v5 offset:32768
    ds_read_b64_tr_b16 v[32:33], v9 offset:16384
    ds_read_b64_tr_b16 v[34:35], v9 offset:16896
    ds_read_b64_tr_b16 v[36:37], v24 offset:16384
    ds_read_b64_tr_b16 v[38:39], v24 offset:16896
    ds_read_b128 v[228:231], v6 offset:32768
    ds_read_b64_tr_b16 v[40:41], v10 offset:16384
    ds_read_b64_tr_b16 v[42:43], v10 offset:16896
    ds_read_b64_tr_b16 v[44:45], v25 offset:16384
    ds_read_b64_tr_b16 v[46:47], v25 offset:16896
    ds_read_b128 v[232:235], v7 offset:32768
    ds_read_b64_tr_b16 v[48:49], v11 offset:16384
    ds_read_b64_tr_b16 v[50:51], v11 offset:16896
    ds_read_b64_tr_b16 v[52:53], v26 offset:16384
    ds_read_b64_tr_b16 v[54:55], v26 offset:16896
    s_waitcnt lgkmcnt(12)
    v_mfma_f32_32x32x16_bf16 v[96:111], v[32:35], v[224:227], v[96:111]
    ds_read_b128 v[236:239], v8 offset:32768
    ds_read_b64_tr_b16 v[56:57], v12 offset:16384
    ds_read_b64_tr_b16 v[58:59], v12 offset:16896
    s_waitcnt lgkmcnt(13)
    v_mfma_f32_32x32x16_bf16 v[112:127], v[36:39], v[224:227], v[112:127]
    ds_read_b64_tr_b16 v[60:61], v27 offset:16384
    ds_read_b64_tr_b16 v[62:63], v27 offset:16896
    s_waitcnt lgkmcnt(12)
    v_mfma_f32_32x32x16_bf16 v[96:111], v[40:43], v[228:231], v[96:111]
    s_waitcnt lgkmcnt(10)
    v_mfma_f32_32x32x16_bf16 v[112:127], v[44:47], v[228:231], v[112:127]
    s_waitcnt lgkmcnt(7)
    v_mfma_f32_32x32x16_bf16 v[96:111], v[48:51], v[232:235], v[96:111]
    s_waitcnt lgkmcnt(5)
    v_mfma_f32_32x32x16_bf16 v[112:127], v[52:55], v[232:235], v[112:127]
    s_waitcnt lgkmcnt(2)
    v_mfma_f32_32x32x16_bf16 v[96:111], v[56:59], v[236:239], v[96:111]
    s_waitcnt lgkmcnt(0)
    v_mfma_f32_32x32x16_bf16 v[112:127], v[60:63], v[236:239], v[112:127]
    v_dot2c_f32_bf16 v17, s3, v32
    v_dot2c_f32_bf16 v28, s3, v36
    v_dot2c_f32_bf16 v17, s3, v33
    v_dot2c_f32_bf16 v28, s3, v37
    v_dot2c_f32_bf16 v17, s3, v34
    v_dot2c_f32_bf16 v28, s3, v38
    v_dot2c_f32_bf16 v17, s3, v35
    v_dot2c_f32_bf16 v28, s3, v39
    s_waitcnt lgkmcnt(0)
    s_barrier
    ds_read_b128 v[240:243], v5 offset:49152
    ds_read_b64_tr_b16 v[64:65], v9 offset:24576
    ds_read_b64_tr_b16 v[66:67], v9 offset:25088
    ds_read_b64_tr_b16 v[68:69], v24 offset:24576
    ds_read_b64_tr_b16 v[70:71], v24 offset:25088
    ds_read_b128 v[244:247], v6 offset:49152
    ds_read_b64_tr_b16 v[76:77], v25 offset:24576
    ds_read_b64_tr_b16 v[78:79], v25 offset:25088
    ds_read_b128 v[248:251], v7 offset:49152
    ds_read_b64_tr_b16 v[84:85], v26 offset:24576
    ds_read_b64_tr_b16 v[86:87], v26 offset:25088
    ds_read_b128 v[252:255], v8 offset:49152
    ds_read_b64_tr_b16 v[92:93], v27 offset:24576
    ds_read_b64_tr_b16 v[94:95], v27 offset:25088
    s_waitcnt vmcnt(0)
    v_cmp_ne_u64 vcc, s[46:47], v[18:19]
    s_cbranch_vccnz Lg1_4
Lg1r_5:
    v_mov_b32 v44, v20
    v_mov_b32 v45, v20
    v_mov_b32 v46, v20
    v_mov_b32 v47, v20
    s_waitcnt lgkmcnt(9)
    v_dot2c_f32_bf16 v17, s3, v64
    v_dot2c_f32_bf16 v28, s3, v68
    v_dot2c_f32_bf16 v17, s3, v65
    v_dot2c_f32_bf16 v28, s3, v69
    v_dot2c_f32_bf16 v17, s3, v66
    v_dot2c_f32_bf16 v28, s3, v70
    v_dot2c_f32_bf16 v17, s3, v67
    v_dot2c_f32_bf16 v28, s3, v71
    v_mfma_f32_32x32x16_bf16 v[112:127], v[68:71], v[240:243], v[112:127]
    s_nop 1
    v_cvt_pk_bf16_f32 v32, v28, v28
    v_and_b32 v32, 0xffff0000, v32
    v_sub_f32 v28, v28, v32
    v_cvt_pk_bf16_f32 v28, v32, v28
    ds_write_b32 v31, v28 offset:1024
    s_waitcnt lgkmcnt(7)
    v_mfma_f32_32x32x16_bf16 v[112:127], v[76:79], v[244:247], v[112:127]
    v_cvt_pk_bf16_f32 v32, v17, v17
    v_and_b32 v32, 0xffff0000, v32
    v_sub_f32 v17, v17, v32
    v_cvt_pk_bf16_f32 v17, v32, v17
    ds_write_b32 v31, v17
    s_waitcnt lgkmcnt(5)
    v_mfma_f32_32x32x16_bf16 v[112:127], v[84:87], v[248:251], v[112:127]
    s_waitcnt lgkmcnt(0)
    s_barrier
    ds_read_b128 v[40:43], v2 offset:1024
    v_mfma_f32_32x32x16_bf16 v[112:127], v[92:95], v[252:255], v[112:127]
    ds_read_b64_tr_b16 v[72:73], v10 offset:24576
    ds_read_b64_tr_b16 v[74:75], v10 offset:25088
    ds_read_b64_tr_b16 v[80:81], v11 offset:24576
    ds_read_b64_tr_b16 v[82:83], v11 offset:25088
    v_mfma_f32_32x32x16_bf16 v[96:111], v[64:67], v[240:243], v[96:111]
    ds_read_b64_tr_b16 v[88:89], v12 offset:24576
    ds_read_b64_tr_b16 v[90:91], v12 offset:25088
    s_waitcnt lgkmcnt(6)
    v_mfma_f32_32x32x16_bf16 v[112:127], v[40:43], v[44:47], v[112:127]
    ds_read_b128 v[36:39], v2
    v_mov_b32 v24, 106512
    ds_read_b128 v[24:27], v24
    v_mov_b32 v12, s63
    s_waitcnt lgkmcnt(6)
    v_mfma_f32_32x32x16_bf16 v[96:111], v[72:75], v[244:247], v[96:111]
    s_nop 3
    s_waitcnt lgkmcnt(2)
    v_mfma_f32_32x32x16_bf16 v[96:111], v[80:83], v[248:251], v[96:111]
    v_mul_f32 v112, v21, v112
    v_mul_f32 v113, v21, v113
    v_mul_f32 v114, v21, v114
    v_mul_f32 v115, v21, v115
    v_mul_f32 v116, v21, v116
    v_mul_f32 v117, v21, v117
    v_mfma_f32_32x32x16_bf16 v[96:111], v[88:91], v[252:255], v[96:111]
    v_mul_f32 v118, v21, v118
    v_mul_f32 v119, v21, v119
    v_mul_f32 v120, v21, v120
    v_mul_f32 v121, v21, v121
    v_mul_f32 v122, v21, v122
    s_waitcnt lgkmcnt(0)
    v_mfma_f32_32x32x16_bf16 v[96:111], v[36:39], v[44:47], v[96:111]
    v_mul_f32 v123, v21, v123
    v_mul_f32 v124, v21, v124
    v_mul_f32 v125, v21, v125
    v_mul_f32 v126, v21, v126
    v_mul_f32 v127, v21, v127
    v_cvt_pk_bf16_f32 v112, v112, v113
    v_cvt_pk_bf16_f32 v113, v114, v115
    v_cvt_pk_bf16_f32 v114, v116, v117
    v_cvt_pk_bf16_f32 v115, v118, v119
    v_cvt_pk_bf16_f32 v116, v120, v121
    v_cvt_pk_bf16_f32 v117, v122, v123
    v_cvt_pk_bf16_f32 v118, v124, v125
    v_cvt_pk_bf16_f32 v119, v126, v127
    s_add_u32 s58, s60, 262144
    buffer_store_dwordx4 v[112:115], v4, s[12:15], s58 offen sc1
    s_add_u32 s58, s60, 393216
    buffer_store_dwordx4 v[116:119], v4, s[12:15], s58 offen sc1
    v_pk_mul_f32 v[64:65], v[96:97], v[20:21] op_sel:[0,1] op_sel_hi:[1,1]
    v_pk_mul_f32 v[66:67], v[98:99], v[20:21] op_sel:[0,1] op_sel_hi:[1,1]
    v_pk_mul_f32 v[68:69], v[100:101], v[20:21] op_sel:[0,1] op_sel_hi:[1,1]
    v_pk_mul_f32 v[70:71], v[102:103], v[20:21] op_sel:[0,1] op_sel_hi:[1,1]
    v_pk_mul_f32 v[72:73], v[104:105], v[20:21] op_sel:[0,1] op_sel_hi:[1,1]
    v_pk_mul_f32 v[74:75], v[106:107], v[20:21] op_sel:[0,1] op_sel_hi:[1,1]
    v_pk_mul_f32 v[76:77], v[108:109], v[20:21] op_sel:[0,1] op_sel_hi:[1,1]
    v_pk_mul_f32 v[78:79], v[110:111], v[20:21] op_sel:[0,1] op_sel_hi:[1,1]
    v_cvt_pk_bf16_f32 v120, v64, v65
    v_cvt_pk_bf16_f32 v121, v66, v67
    v_cvt_pk_bf16_f32 v122, v68, v69
    v_cvt_pk_bf16_f32 v123, v70, v71
    v_cvt_pk_bf16_f32 v124, v72, v73
    v_cvt_pk_bf16_f32 v125, v74, v75
    v_cvt_pk_bf16_f32 v126, v76, v77
    v_cvt_pk_bf16_f32 v127, v78, v79
    s_add_u32 s58, s60, 0
    buffer_store_dwordx4 v[120:123], v4, s[12:15], s58 offen sc1
    s_add_u32 s58, s60, 131072
    buffer_store_dwordx4 v[124:127], v4, s[12:15], s58 offen sc1
    v_and_b32 v24, v24, v25
    v_and_b32 v26, v26, v27
    v_and_b32 v24, v24, v26
    s_nop 0
    v_readfirstlane_b32 s30, v24
    v_mov_b32 v63, s64
    s_branch L_a_done
L_typeV:
    s_waitcnt lgkmcnt(0)
    s_barrier
    ds_read_b128 v[128:131], v5 offset:0
    ds_read_b64_tr_b16 v[32:33], v9 offset:0
    ds_read_b64_tr_b16 v[34:35], v9 offset:512
    ds_read_b64_tr_b16 v[36:37], v24 offset:0
    ds_read_b64_tr_b16 v[38:39], v24 offset:512
    ds_read_b128 v[132:135], v6 offset:0
    ds_read_b64_tr_b16 v[40:41], v10 offset:0
    ds_read_b64_tr_b16 v[42:43], v10 offset:512
    ds_read_b64_tr_b16 v[44:45], v25 offset:0
    ds_read_b64_tr_b16 v[46:47], v25 offset:512
    s_waitcnt vmcnt(1)
    v_dot2c_f32_bf16 v18, s3, v64
    v_dot2c_f32_bf16 v19, v64, v64
    v_dot2c_f32_bf16 v18, s3, v65
    v_dot2c_f32_bf16 v19, v65, v65
    v_dot2c_f32_bf16 v18, s3, v66
    v_dot2c_f32_bf16 v19, v66, v66
    v_dot2c_f32_bf16 v18, s3, v67
    v_dot2c_f32_bf16 v19, v67, v67
    v_dot2c_f32_bf16 v18, s3, v68
    v_dot2c_f32_bf16 v19, v68, v68
    v_dot2c_f32_bf16 v18, s3, v69
    v_dot2c_f32_bf16 v19, v69, v69
    v_dot2c_f32_bf16 v18, s3, v70
    v_dot2c_f32_bf16 v19, v70, v70
    v_dot2c_f32_bf16 v18, s3, v71
    v_dot2c_f32_bf16 v19, v71, v71
    s_waitcnt lgkmcnt(7)
    v_mfma_f32_32x32x16_bf16 v[96:111], v[128:131], v[32:35], 0
    ds_read_b128 v[136:139], v7 offset:0
    ds_read_b64_tr_b16 v[48:49], v11 offset:0
    ds_read_b64_tr_b16 v[50:51], v11 offset:512
    v_add_f32_dpp v18, v18, v18 row_ror:8 row_mask:0xf bank_mask:0xf
    v_add_f32_dpp v19, v19, v19 row_ror:8 row_mask:0xf bank_mask:0xf
    s_nop 0
    v_add_f32_dpp v18, v18, v18 row_ror:4 row_mask:0xf bank_mask:0xf
    s_waitcnt lgkmcnt(8)
    v_mfma_f32_32x32x16_bf16 v[112:127], v[128:131], v[36:39], 0
    ds_read_b64_tr_b16 v[52:53], v26 offset:0
    ds_read_b64_tr_b16 v[54:55], v26 offset:512
    v_add_f32_dpp v19, v19, v19 row_ror:4 row_mask:0xf bank_mask:0xf
    v_add_f32_dpp v18, v18, v18 row_ror:2 row_mask:0xf bank_mask:0xf
    s_nop 0
    v_add_f32_dpp v19, v19, v19 row_ror:2 row_mask:0xf bank_mask:0xf
    s_waitcnt lgkmcnt(7)
    v_mfma_f32_32x32x16_bf16 v[96:111], v[132:135], v[40:43], v[96:111]
    ds_read_b128 v[140:143], v8 offset:0
    ds_read_b64_tr_b16 v[56:57], v12 offset:0
    ds_read_b64_tr_b16 v[58:59], v12 offset:512
    v_add_f32_dpp v18, v18, v18 row_ror:1 row_mask:0xf bank_mask:0xf
    v_add_f32_dpp v19, v19, v19 row_ror:1 row_mask:0xf bank_mask:0xf
    v_mov_b32 v64, v18
    s_waitcnt lgkmcnt(8)
    v_mfma_f32_32x32x16_bf16 v[112:127], v[132:135], v[44:47], v[112:127]
    ds_read_b64_tr_b16 v[60:61], v27 offset:0
    ds_read_b64_tr_b16 v[62:63], v27 offset:512
    v_mov_b32 v65, v19
    v_permlane16_swap_b32 v64, v18
    s_nop 0
    v_permlane16_swap_b32 v65, v19
    s_waitcnt lgkmcnt(7)
    v_mfma_f32_32x32x16_bf16 v[96:111], v[136:139], v[48:51], v[96:111]
    v_add_f32 v18, v64, v18
    v_add_f32 v19, v65, v19
    v_mul_f32 v18, 0x3b000000, v18
    v_cvt_pk_bf16_f32 v70, -v18, -v18
    v_mul_f32 v19, 0x3b000000, v19
    v_fma_f32 v19, -v18, v18, v19
    s_waitcnt lgkmcnt(5)
    v_mfma_f32_32x32x16_bf16 v[112:127], v[136:139], v[52:55], v[112:127]
    v_max_f32 v19, 0, v19
    v_cvt_pk_bf16_f32 v19, v19, v19
    v_and_b32 v19, 0xffff0000, v19
    v_add_f32 v19, 0x3727c5ac, v19
    v_cvt_pk_bf16_f32 v19, v19, v19
    v_and_b32 v19, 0xffff0000, v19
    s_waitcnt lgkmcnt(2)
    v_mfma_f32_32x32x16_bf16 v[96:111], v[140:143], v[56:59], v[96:111]
    v_sqrt_f32 v19, v19
    s_nop 0
    v_cvt_pk_bf16_f32 v64, v19, v19
    v_and_b32 v64, 0xffff0000, v64
    v_rcp_f32 v71, v64
    v_mov_b32 v68, v22
    v_mov_b32 v69, v23
    s_waitcnt lgkmcnt(0)
    v_mfma_f32_32x32x16_bf16 v[112:127], v[140:143], v[60:63], v[112:127]
    v_lshlrev_b32 v2, 4, v1
    v_add_u32 v2, 106560, v2
    s_mov_b32 exec_lo, 1
    s_mov_b32 exec_hi, 1
    ds_write_b128 v75, v[68:71]
    s_mov_b64 exec, -1
    v_dot2c_f32_bf16 v17, s3, v32
    v_dot2c_f32_bf16 v28, s3, v36
    v_dot2c_f32_bf16 v17, s3, v33
    v_dot2c_f32_bf16 v28, s3, v37
    v_dot2c_f32_bf16 v17, s3, v34
    v_dot2c_f32_bf16 v28, s3, v38
    v_dot2c_f32_bf16 v17, s3, v35
    v_dot2c_f32_bf16 v28, s3, v39
    s_waitcnt lgkmcnt(0)
    s_barrier
    ds_read_b128 v[144:147], v5 offset:16384
    ds_read_b64_tr_b16 v[64:65], v9 offset:8192
    ds_read_b64_tr_b16 v[66:67], v9 offset:8704
    ds_read_b64_tr_b16 v[68:69], v24 offset:8192
    ds_read_b64_tr_b16 v[70:71], v24 offset:8704
    ds_read_b128 v[148:151], v6 offset:16384
    ds_read_b64_tr_b16 v[72:73], v10 offset:8192
    ds_read_b64_tr_b16 v[74:75], v10 offset:8704
    ds_read_b64_tr_b16 v[76:77], v25 offset:8192
    ds_read_b64_tr_b16 v[78:79], v25 offset:8704
    ds_read_b128 v[18:21], v2
    s_waitcnt lgkmcnt(8)
    v_mfma_f32_32x32x16_bf16 v[96:111], v[144:147], v[64:67], v[96:111]
    ds_read_b128 v[152:155], v7 offset:16384
    ds_read_b64_tr_b16 v[80:81], v11 offset:8192
    ds_read_b64_tr_b16 v[82:83], v11 offset:8704
    s_waitcnt lgkmcnt(9)
    v_mfma_f32_32x32x16_bf16 v[112:127], v[144:147], v[68:71], v[112:127]
    ds_read_b64_tr_b16 v[84:85], v26 offset:8192
    ds_read_b64_tr_b16 v[86:87], v26 offset:8704
    s_waitcnt lgkmcnt(8)
    v_mfma_f32_32x32x16_bf16 v[96:111], v[148:151], v[72:75], v[96:111]
    ds_read_b128 v[156:159], v8 offset:16384
    ds_read_b64_tr_b16 v[88:89], v12 offset:8192
    ds_read_b64_tr_b16 v[90:91], v12 offset:8704
    s_waitcnt lgkmcnt(9)
    v_mfma_f32_32x32x16_bf16 v[112:127], v[148:151], v[76:79], v[112:127]
    ds_read_b64_tr_b16 v[92:93], v27 offset:8192
    ds_read_b64_tr_b16 v[94:95], v27 offset:8704
    s_waitcnt lgkmcnt(7)
    v_mfma_f32_32x32x16_bf16 v[96:111], v[152:155], v[80:83], v[96:111]
    s_waitcnt lgkmcnt(10)
    s_mov_b64 exec, 0xff
    buffer_store_dwordx4 v[18:21], v30, s[12:15], 0 offen sc1
    s_mov_b64 exec, -1
    s_waitcnt lgkmcnt(5)
    v_mfma_f32_32x32x16_bf16 v[112:127], v[152:155], v[84:87], v[112:127]
    s_waitcnt lgkmcnt(2)
    v_mfma_f32_32x32x16_bf16 v[96:111], v[156:159], v[88:91], v[96:111]
    s_waitcnt lgkmcnt(0)
    v_mfma_f32_32x32x16_bf16 v[112:127], v[156:159], v[92:95], v[112:127]
    v_dot2c_f32_bf16 v17, s3, v64
    v_dot2c_f32_bf16 v28, s3, v68
    v_dot2c_f32_bf16 v17, s3, v65
    v_dot2c_f32_bf16 v28, s3, v69
    v_dot2c_f32_bf16 v17, s3, v66
    v_dot2c_f32_bf16 v28, s3, v70
    v_dot2c_f32_bf16 v17, s3, v67
    v_dot2c_f32_bf16 v28, s3, v71
    s_waitcnt lgkmcnt(0)
    s_barrier
    ds_read_b128 v[160:163], v5 offset:32768
    ds_read_b64_tr_b16 v[32:33], v9 offset:16384
    ds_read_b64_tr_b16 v[34:35], v9 offset:16896
    ds_read_b64_tr_b16 v[36:37], v24 offset:16384
    ds_read_b64_tr_b16 v[38:39], v24 offset:16896
    ds_read_b128 v[164:167], v6 offset:32768
    ds_read_b64_tr_b16 v[40:41], v10 offset:16384
    ds_read_b64_tr_b16 v[42:43], v10 offset:16896
    ds_read_b64_tr_b16 v[44:45], v25 offset:16384
    ds_read_b64_tr_b16 v[46:47], v25 offset:16896
    ds_read_b128 v[168:171], v7 offset:32768
    ds_read_b64_tr_b16 v[48:49], v11 offset:16384
    ds_read_b64_tr_b16 v[50:51], v11 offset:16896
    ds_read_b64_tr_b16 v[52:53], v26 offset:16384
    ds_read_b64_tr_b16 v[54:55], v26 offset:16896
    s_waitcnt lgkmcnt(12)
    v_mfma_f32_32x32x16_bf16 v[96:111], v[160:163], v[32:35], v[96:111]
    ds_read_b128 v[172:175], v8 offset:32768
    ds_read_b64_tr_b16 v[56:57], v12 offset:16384
    ds_read_b64_tr_b16 v[58:59], v12 offset:16896
    s_waitcnt lgkmcnt(13)
    v_mfma_f32_32x32x16_bf16 v[112:127], v[160:163], v[36:39], v[112:127]
    ds_read_b64_tr_b16 v[60:61], v27 offset:16384
    ds_read_b64_tr_b16 v[62:63], v27 offset:16896
    s_waitcnt lgkmcnt(12)
    v_mfma_f32_32x32x16_bf16 v[96:111], v[164:167], v[40:43], v[96:111]
    s_waitcnt lgkmcnt(10)
    v_mfma_f32_32x32x16_bf16 v[112:127], v[164:167], v[44:47], v[112:127]
    s_waitcnt lgkmcnt(7)
    v_mfma_f32_32x32x16_bf16 v[96:111], v[168:171], v[48:51], v[96:111]
    s_waitcnt lgkmcnt(5)
    v_mfma_f32_32x32x16_bf16 v[112:127], v[168:171], v[52:55], v[112:127]
    s_waitcnt lgkmcnt(2)
    v_mfma_f32_32x32x16_bf16 v[96:111], v[172:175], v[56:59], v[96:111]
    s_waitcnt lgkmcnt(0)
    v_mfma_f32_32x32x16_bf16 v[112:127], v[172:175], v[60:63], v[112:127]
    v_dot2c_f32_bf16 v17, s3, v32
    v_dot2c_f32_bf16 v28, s3, v36
    v_dot2c_f32_bf16 v17, s3, v33
    v_dot2c_f32_bf16 v28, s3, v37
    v_dot2c_f32_bf16 v17, s3, v34
    v_dot2c_f32_bf16 v28, s3, v38
    v_dot2c_f32_bf16 v17, s3, v35
    v_dot2c_f32_bf16 v28, s3, v39
    s_waitcnt lgkmcnt(0)
    s_barrier
    ds_read_b128 v[176:179], v5 offset:49152
    ds_read_b64_tr_b16 v[64:65], v9 offset:24576
    ds_read_b64_tr_b16 v[66:67], v9 offset:25088
    ds_read_b64_tr_b16 v[68:69], v24 offset:24576
    ds_read_b64_tr_b16 v[70:71], v24 offset:25088
    ds_read_b128 v[180:183], v6 offset:49152
    ds_read_b64_tr_b16 v[72:73], v10 offset:24576
    ds_read_b64_tr_b16 v[74:75], v10 offset:25088
    ds_read_b64_tr_b16 v[76:77], v25 offset:24576
    ds_read_b64_tr_b16 v[78:79], v25 offset:25088
    ds_read_b128 v[184:187], v7 offset:49152
    ds_read_b64_tr_b16 v[80:81], v11 offset:24576
    ds_read_b64_tr_b16 v[82:83], v11 offset:25088
    ds_read_b64_tr_b16 v[84:85], v26 offset:24576
    ds_read_b64_tr_b16 v[86:87], v26 offset:25088
    s_waitcnt lgkmcnt(12)
    v_mfma_f32_32x32x16_bf16 v[96:111], v[176:179], v[64:67], v[96:111]
    ds_read_b128 v[188:191], v8 offset:49152
    ds_read_b64_tr_b16 v[88:89], v12 offset:24576
    ds_read_b64_tr_b16 v[90:91], v12 offset:25088
    s_lshl_b32 s58, s49, 7
    s_add_u32 s58, s58, 111616
    v_lshrrev_b32 v2, 5, v1
    s_waitcnt lgkmcnt(13)
    v_mfma_f32_32x32x16_bf16 v[112:127], v[176:179], v[68:71], v[112:127]
    ds_read_b64_tr_b16 v[92:93], v27 offset:24576
    ds_read_b64_tr_b16 v[94:95], v27 offset:25088
    v_lshl_add_u32 v30, v2, 4, s58
    v_and_b32 v4, 15, v1
    v_lshl_add_u32 v4, v2, 4, v4
    s_waitcnt lgkmcnt(12)
    v_mfma_f32_32x32x16_bf16 v[96:111], v[180:183], v[72:75], v[96:111]
    v_lshlrev_b32 v4, 4, v4
    v_bfe_u32 v2, v1, 4, 1
    v_lshl_add_u32 v4, v2, 17, v4
    s_waitcnt lgkmcnt(10)
    v_mfma_f32_32x32x16_bf16 v[112:127], v[180:183], v[76:79], v[112:127]
    s_waitcnt vmcnt(1)
    v_and_b32 v3, 31, v1
    v_lshl_add_u32 v3, v3, 2, s58
    s_waitcnt lgkmcnt(7)
    v_mfma_f32_32x32x16_bf16 v[96:111], v[184:187], v[80:83], v[96:111]
    v_lshlrev_b32 v2, 4, v1
    v_add_u32 v2, 108544, v2
    s_waitcnt lgkmcnt(5)
    v_mfma_f32_32x32x16_bf16 v[112:127], v[184:187], v[84:87], v[112:127]
    s_waitcnt lgkmcnt(2)
    v_mfma_f32_32x32x16_bf16 v[96:111], v[188:191], v[88:91], v[96:111]
    s_waitcnt lgkmcnt(0)
    v_mfma_f32_32x32x16_bf16 v[112:127], v[188:191], v[92:95], v[112:127]
    v_dot2c_f32_bf16 v17, s3, v64
    v_dot2c_f32_bf16 v28, s3, v68
    v_dot2c_f32_bf16 v17, s3, v65
    v_dot2c_f32_bf16 v28, s3, v69
    v_dot2c_f32_bf16 v17, s3, v66
    v_dot2c_f32_bf16 v28, s3, v70
    v_dot2c_f32_bf16 v17, s3, v67
    v_dot2c_f32_bf16 v28, s3, v71
    s_waitcnt lgkmcnt(0)
    s_barrier
    buffer_load_dwordx4 v[18:21], v29, s[12:15], 0 offen sc1
    ds_read_b128 v[192:195], v5 offset:0
    ds_read_b64_tr_b16 v[32:33], v9 offset:0
    ds_read_b64_tr_b16 v[34:35], v9 offset:512
    ds_read_b64_tr_b16 v[36:37], v24 offset:0
    ds_read_b64_tr_b16 v[38:39], v24 offset:512
    ds_read_b128 v[196:199], v6 offset:0
    ds_read_b64_tr_b16 v[40:41], v10 offset:0
    ds_read_b64_tr_b16 v[42:43], v10 offset:512
    ds_read_b64_tr_b16 v[44:45], v25 offset:0
    ds_read_b64_tr_b16 v[46:47], v25 offset:512
    ds_read_b128 v[200:203], v7 offset:0
    ds_read_b64_tr_b16 v[48:49], v11 offset:0
    ds_read_b64_tr_b16 v[50:51], v11 offset:512
    ds_read_b64_tr_b16 v[52:53], v26 offset:0
    ds_read_b64_tr_b16 v[54:55], v26 offset:512
    s_waitcnt lgkmcnt(12)
    v_mfma_f32_32x32x16_bf16 v[96:111], v[192:195], v[32:35], v[96:111]
    ds_read_b128 v[204:207], v8 offset:0
    ds_read_b64_tr_b16 v[56:57], v12 offset:0
    ds_read_b64_tr_b16 v[58:59], v12 offset:512
    s_waitcnt lgkmcnt(13)
    v_mfma_f32_32x32x16_bf16 v[112:127], v[192:195], v[36:39], v[112:127]
    ds_read_b64_tr_b16 v[60:61], v27 offset:0
    ds_read_b64_tr_b16 v[62:63], v27 offset:512
    s_waitcnt lgkmcnt(12)
    v_mfma_f32_32x32x16_bf16 v[96:111], v[196:199], v[40:43], v[96:111]
    s_waitcnt lgkmcnt(10)
    v_mfma_f32_32x32x16_bf16 v[112:127], v[196:199], v[44:47], v[112:127]
    s_waitcnt lgkmcnt(7)
    v_mfma_f32_32x32x16_bf16 v[96:111], v[200:203], v[48:51], v[96:111]
    s_waitcnt lgkmcnt(5)
    v_mfma_f32_32x32x16_bf16 v[112:127], v[200:203], v[52:55], v[112:127]
    s_waitcnt lgkmcnt(2)
    v_mfma_f32_32x32x16_bf16 v[96:111], v[204:207], v[56:59], v[96:111]
    s_waitcnt lgkmcnt(0)
    v_mfma_f32_32x32x16_bf16 v[112:127], v[204:207], v[60:63], v[112:127]
    v_dot2c_f32_bf16 v17, s3, v32
    v_dot2c_f32_bf16 v28, s3, v36
    v_dot2c_f32_bf16 v17, s3, v33
    v_dot2c_f32_bf16 v28, s3, v37
    v_dot2c_f32_bf16 v17, s3, v34
    v_dot2c_f32_bf16 v28, s3, v38
    v_dot2c_f32_bf16 v17, s3, v35
    v_dot2c_f32_bf16 v28, s3, v39
    s_waitcnt lgkmcnt(0)
    s_barrier
    ds_read_b128 v[208:211], v5 offset:16384
    ds_read_b64_tr_b16 v[64:65], v9 offset:8192
    ds_read_b64_tr_b16 v[66:67], v9 offset:8704
    ds_read_b64_tr_b16 v[68:69], v24 offset:8192
    ds_read_b64_tr_b16 v[70:71], v24 offset:8704
    ds_read_b128 v[212:215], v6 offset:16384
    ds_read_b64_tr_b16 v[72:73], v10 offset:8192
    ds_read_b64_tr_b16 v[74:75], v10 offset:8704
    ds_read_b64_tr_b16 v[76:77], v25 offset:8192
    ds_read_b64_tr_b16 v[78:79], v25 offset:8704
    ds_read_b128 v[216:219], v7 offset:16384
    ds_read_b64_tr_b16 v[80:81], v11 offset:8192
    ds_read_b64_tr_b16 v[82:83], v11 offset:8704
    ds_read_b64_tr_b16 v[84:85], v26 offset:8192
    ds_read_b64_tr_b16 v[86:87], v26 offset:8704
    s_waitcnt lgkmcnt(12)
    v_mfma_f32_32x32x16_bf16 v[96:111], v[208:211], v[64:67], v[96:111]
    ds_read_b128 v[220:223], v8 offset:16384
    ds_read_b64_tr_b16 v[88:89], v12 offset:8192
    ds_read_b64_tr_b16 v[90:91], v12 offset:8704
    s_waitcnt lgkmcnt(13)
    v_mfma_f32_32x32x16_bf16 v[112:127], v[208:211], v[68:71], v[112:127]
    ds_read_b64_tr_b16 v[92:93], v27 offset:8192
    ds_read_b64_tr_b16 v[94:95], v27 offset:8704
    s_waitcnt lgkmcnt(12)
    v_mfma_f32_32x32x16_bf16 v[96:111], v[212:215], v[72:75], v[96:111]
    s_waitcnt lgkmcnt(10)
    v_mfma_f32_32x32x16_bf16 v[112:127], v[212:215], v[76:79], v[112:127]
    s_waitcnt lgkmcnt(7)
    v_mfma_f32_32x32x16_bf16 v[96:111], v[216:219], v[80:83], v[96:111]
    s_waitcnt lgkmcnt(5)
    v_mfma_f32_32x32x16_bf16 v[112:127], v[216:219], v[84:87], v[112:127]
    s_waitcnt lgkmcnt(2)
    v_mfma_f32_32x32x16_bf16 v[96:111], v[220:223], v[88:91], v[96:111]
    s_waitcnt lgkmcnt(0)
    v_mfma_f32_32x32x16_bf16 v[112:127], v[220:223], v[92:95], v[112:127]
    v_dot2c_f32_bf16 v17, s3, v64
    v_dot2c_f32_bf16 v28, s3, v68
    v_dot2c_f32_bf16 v17, s3, v65
    v_dot2c_f32_bf16 v28, s3, v69
    v_dot2c_f32_bf16 v17, s3, v66
    v_dot2c_f32_bf16 v28, s3, v70
    v_dot2c_f32_bf16 v17, s3, v67
    v_dot2c_f32_bf16 v28, s3, v71
    s_waitcnt lgkmcnt(0)
    s_barrier
    ds_read_b128 v[224:227], v5 offset:32768
    ds_read_b64_tr_b16 v[32:33], v9 offset:16384
    ds_read_b64_tr_b16 v[34:35], v9 offset:16896
    ds_read_b64_tr_b16 v[36:37], v24 offset:16384
    ds_read_b64_tr_b16 v[38:39], v24 offset:16896
    ds_read_b128 v[228:231], v6 offset:32768
    ds_read_b64_tr_b16 v[40:41], v10 offset:16384
    ds_read_b64_tr_b16 v[42:43], v10 offset:16896
    ds_read_b64_tr_b16 v[44:45], v25 offset:16384
    ds_read_b64_tr_b16 v[46:47], v25 offset:16896
    ds_read_b128 v[232:235], v7 offset:32768
    ds_read_b64_tr_b16 v[48:49], v11 offset:16384
    ds_read_b64_tr_b16 v[50:51], v11 offset:16896
    ds_read_b64_tr_b16 v[52:53], v26 offset:16384
    ds_read_b64_tr_b16 v[54:55], v26 offset:16896
    s_waitcnt lgkmcnt(12)
    v_mfma_f32_32x32x16_bf16 v[96:111], v[224:227], v[32:35], v[96:111]
    ds_read_b128 v[236:239], v8 offset:32768
    ds_read_b64_tr_b16 v[56:57], v12 offset:16384
    ds_read_b64_tr_b16 v[58:59], v12 offset:16896
    s_waitcnt lgkmcnt(13)
    v_mfma_f32_32x32x16_bf16 v[112:127], v[224:227], v[36:39], v[112:127]
    ds_read_b64_tr_b16 v[60:61], v27 offset:16384
    ds_read_b64_tr_b16 v[62:63], v27 offset:16896
    s_waitcnt lgkmcnt(12)
    v_mfma_f32_32x32x16_bf16 v[96:111], v[228:231], v[40:43], v[96:111]
    s_waitcnt lgkmcnt(10)
    v_mfma_f32_32x32x16_bf16 v[112:127], v[228:231], v[44:47], v[112:127]
    s_waitcnt lgkmcnt(7)
    v_mfma_f32_32x32x16_bf16 v[96:111], v[232:235], v[48:51], v[96:111]
    s_waitcnt lgkmcnt(5)
    v_mfma_f32_32x32x16_bf16 v[112:127], v[232:235], v[52:55], v[112:127]
    s_waitcnt lgkmcnt(2)
    v_mfma_f32_32x32x16_bf16 v[96:111], v[236:239], v[56:59], v[96:111]
    s_waitcnt lgkmcnt(0)
    v_mfma_f32_32x32x16_bf16 v[112:127], v[236:239], v[60:63], v[112:127]
    v_dot2c_f32_bf16 v17, s3, v32
    v_dot2c_f32_bf16 v28, s3, v36
    v_dot2c_f32_bf16 v17, s3, v33
    v_dot2c_f32_bf16 v28, s3, v37
    v_dot2c_f32_bf16 v17, s3, v34
    v_dot2c_f32_bf16 v28, s3, v38
    v_dot2c_f32_bf16 v17, s3, v35
    v_dot2c_f32_bf16 v28, s3, v39
    s_waitcnt lgkmcnt(0)
    s_barrier
    ds_read_b128 v[240:243], v5 offset:49152
    ds_read_b64_tr_b16 v[64:65], v9 offset:24576
    ds_read_b64_tr_b16 v[66:67], v9 offset:25088
    ds_read_b64_tr_b16 v[68:69], v24 offset:24576
    ds_read_b64_tr_b16 v[70:71], v24 offset:25088
    ds_read_b128 v[244:247], v6 offset:49152
    ds_read_b64_tr_b16 v[76:77], v25 offset:24576
    ds_read_b64_tr_b16 v[78:79], v25 offset:25088
    ds_read_b128 v[248:251], v7 offset:49152
    ds_read_b64_tr_b16 v[84:85], v26 offset:24576
    ds_read_b64_tr_b16 v[86:87], v26 offset:25088
    ds_read_b128 v[252:255], v8 offset:49152
    ds_read_b64_tr_b16 v[92:93], v27 offset:24576
    ds_read_b64_tr_b16 v[94:95], v27 offset:25088
    s_waitcnt vmcnt(0)
    v_cmp_ne_u64 vcc, s[46:47], v[18:19]
    s_cbranch_vccnz Lg1_6
Lg1r_7:
    ds_write_b32 v3, v21
    v_mov_b32 v44, v20
    v_mov_b32 v45, v20
    v_mov_b32 v46, v20
    v_mov_b32 v47, v20
    s_waitcnt lgkmcnt(10)
    v_dot2c_f32_bf16 v17, s3, v64
    v_dot2c_f32_bf16 v28, s3, v68
    v_dot2c_f32_bf16 v17, s3, v65
    v_dot2c_f32_bf16 v28, s3, v69
    v_dot2c_f32_bf16 v17, s3, v66
    v_dot2c_f32_bf16 v28, s3, v70
    v_dot2c_f32_bf16 v17, s3, v67
    v_dot2c_f32_bf16 v28, s3, v71
    v_mfma_f32_32x32x16_bf16 v[112:127], v[240:243], v[68:71], v[112:127]
    s_nop 1
    v_cvt_pk_bf16_f32 v32, v28, v28
    v_and_b32 v32, 0xffff0000, v32
    v_sub_f32 v28, v28, v32
    v_cvt_pk_bf16_f32 v28, v32, v28
    ds_write_b32 v31, v28 offset:1024
    s_waitcnt lgkmcnt(8)
    v_mfma_f32_32x32x16_bf16 v[112:127], v[244:247], v[76:79], v[112:127]
    v_cvt_pk_bf16_f32 v32, v17, v17
    v_and_b32 v32, 0xffff0000, v32
    v_sub_f32 v17, v17, v32
    v_cvt_pk_bf16_f32 v17, v32, v17
    ds_write_b32 v31, v17
    s_waitcnt lgkmcnt(6)
    v_mfma_f32_32x32x16_bf16 v[112:127], v[248:251], v[84:87], v[112:127]
    s_waitcnt lgkmcnt(0)
    s_barrier
    ds_read_b128 v[40:43], v2 offset:1024
    v_mfma_f32_32x32x16_bf16 v[112:127], v[252:255], v[92:95], v[112:127]
    ds_read_b64_tr_b16 v[72:73], v10 offset:24576
    ds_read_b64_tr_b16 v[74:75], v10 offset:25088
    ds_read_b64_tr_b16 v[80:81], v11 offset:24576
    ds_read_b64_tr_b16 v[82:83], v11 offset:25088
    v_mfma_f32_32x32x16_bf16 v[96:111], v[240:243], v[64:67], v[96:111]
    ds_read_b128 v[48:51], v30 offset:0
    ds_read_b128 v[52:55], v30 offset:32
    ds_read_b128 v[56:59], v30 offset:64
    ds_read_b128 v[60:63], v30 offset:96
    ds_read_b64_tr_b16 v[88:89], v12 offset:24576
    ds_read_b64_tr_b16 v[90:91], v12 offset:25088
    s_waitcnt lgkmcnt(10)
    v_mfma_f32_32x32x16_bf16 v[112:127], v[44:47], v[40:43], v[112:127]
    ds_read_b128 v[36:39], v2
    v_mov_b32 v24, 106512
    ds_read_b128 v[24:27], v24
    v_mov_b32 v12, s63
    s_waitcnt lgkmcnt(10)
    v_mfma_f32_32x32x16_bf16 v[96:111], v[244:247], v[72:75], v[96:111]
    s_nop 3
    s_waitcnt lgkmcnt(2)
    v_mfma_f32_32x32x16_bf16 v[96:111], v[248:251], v[80:83], v[96:111]
    v_mul_f32 v112, v48, v112
    v_mul_f32 v113, v49, v113
    v_mul_f32 v114, v50, v114
    v_mul_f32 v115, v51, v115
    v_mul_f32 v116, v52, v116
    v_mul_f32 v117, v53, v117
    v_mfma_f32_32x32x16_bf16 v[96:111], v[252:255], v[88:91], v[96:111]
    v_mul_f32 v118, v54, v118
    v_mul_f32 v119, v55, v119
    v_mul_f32 v120, v56, v120
    v_mul_f32 v121, v57, v121
    v_mul_f32 v122, v58, v122
    s_waitcnt lgkmcnt(0)
    v_mfma_f32_32x32x16_bf16 v[96:111], v[44:47], v[36:39], v[96:111]
    v_mul_f32 v123, v59, v123
    v_mul_f32 v124, v60, v124
    v_mul_f32 v125, v61, v125
    v_mul_f32 v126, v62, v126
    v_mul_f32 v127, v63, v127
    v_cvt_pk_bf16_f32 v112, v112, v113
    v_cvt_pk_bf16_f32 v113, v114, v115
    v_cvt_pk_bf16_f32 v114, v116, v117
    v_cvt_pk_bf16_f32 v115, v118, v119
    v_cvt_pk_bf16_f32 v116, v120, v121
    v_cvt_pk_bf16_f32 v117, v122, v123
    v_cvt_pk_bf16_f32 v118, v124, v125
    v_cvt_pk_bf16_f32 v119, v126, v127
    s_add_u32 s58, s60, 262144
    buffer_store_dwordx4 v[112:115], v4, s[12:15], s58 offen offset:1024 sc1
    buffer_store_dwordx4 v[116:119], v4, s[12:15], s58 offen offset:1536 sc1
    v_pk_mul_f32 v[64:65], v[96:97], v[48:49]
    v_pk_mul_f32 v[66:67], v[98:99], v[50:51]
    v_pk_mul_f32 v[68:69], v[100:101], v[52:53]
    v_pk_mul_f32 v[70:71], v[102:103], v[54:55]
    v_pk_mul_f32 v[72:73], v[104:105], v[56:57]
    v_pk_mul_f32 v[74:75], v[106:107], v[58:59]
    v_pk_mul_f32 v[76:77], v[108:109], v[60:61]
    v_pk_mul_f32 v[78:79], v[110:111], v[62:63]
    v_cvt_pk_bf16_f32 v120, v64, v65
    v_cvt_pk_bf16_f32 v121, v66, v67
    v_cvt_pk_bf16_f32 v122, v68, v69
    v_cvt_pk_bf16_f32 v123, v70, v71
    v_cvt_pk_bf16_f32 v124, v72, v73
    v_cvt_pk_bf16_f32 v125, v74, v75
    v_cvt_pk_bf16_f32 v126, v76, v77
    v_cvt_pk_bf16_f32 v127, v78, v79
    s_add_u32 s58, s60, 0
    buffer_store_dwordx4 v[120:123], v4, s[12:15], s58 offen offset:1024 sc1
    buffer_store_dwordx4 v[124:127], v4, s[12:15], s58 offen offset:1536 sc1
    v_and_b32 v24, v24, v25
    v_and_b32 v26, v26, v27
    v_and_b32 v24, v24, v26
    s_nop 0
    v_readfirstlane_b32 s30, v24
    v_mov_b32 v63, s64
L_a_done:
    v_mov_b32 v2, 0xdddd
    v_lshlrev_b32 v3, 4, v1
    v_and_b32 v10, 15, v1
    v_lshrrev_b32 v11, 5, v1
    v_lshl_add_u32 v11, v11, 4, v10
    v_lshlrev_b32 v4, 4, v11
    s_lshl_b32 s84, s51, 1
    s_lshr_b32 s58, s54, 1
    s_lshl2_add_u32 s58, s58, s49
    s_lshl_b32 s58, s58, 12
    s_add_u32 s100, s58, 327680
    s_lshl1_add_u32 s58, s54, s50
    s_lshl_b32 s58, s58, 17
    s_lshl_b32 s59, s49, 11
    s_add_u32 s58, s58, s59
    s_add_u32 s68, s58, 2097152
    s_mov_b32 s40, 0xffff
    s_mov_b32 s41, 0xffff
    s_mov_b32 s66, 0
    v_and_b32 v10, 27, v1
    v_cmp_eq_u32 vcc, 16, v10
    v_mov_b32 v11, s3
    s_nop 0
    v_cndmask_b32 v10, 0, v11, vcc
    v_mov_b32 v28, v10
    v_mov_b32 v29, v10
    v_mov_b32 v30, v10
    v_mov_b32 v31, v10
    v_mov_b32 v32, v10
    v_mov_b32 v33, v10
    v_mov_b32 v34, v10
    v_mov_b32 v35, v10
    v_mov_b32 v40, v10
    v_mov_b32 v41, v10
    v_mov_b32 v42, v10
    v_mov_b32 v43, v10
    v_mov_b32 v44, v10
    v_mov_b32 v45, v10
    v_mov_b32 v46, v10
    v_mov_b32 v47, v10
    v_mov_b32 v52, v10
    v_mov_b32 v53, v10
    v_mov_b32 v54, v10
    v_mov_b32 v55, v10
    v_mov_b32 v56, v10
    v_mov_b32 v57, v10
    v_mov_b32 v58, v10
    v_mov_b32 v59, v10
    v_mul_f32 v21, 0x3eb8aa3b, v21
    s_lshl_b32 s58, s49, 10
    s_add_u32 s58, s58, 98304
    v_lshl_add_u32 v60, v1, 4, s58
    v_add_u32 v61, 110592, v3
    s_barrier
    ds_read_b64_tr_b16 v[64:65], v13 offset:0
    ds_read_b64_tr_b16 v[66:67], v13 offset:256
    ds_read_b64_tr_b16 v[68:69], v14 offset:0
    ds_read_b64_tr_b16 v[70:71], v14 offset:256
    ds_read_b64_tr_b16 v[72:73], v15 offset:0
    ds_read_b64_tr_b16 v[74:75], v15 offset:256
    ds_read_b64_tr_b16 v[76:77], v16 offset:0
    ds_read_b64_tr_b16 v[78:79], v16 offset:256
    ds_read_b64_tr_b16 v[80:81], v13 offset:4096
    ds_read_b64_tr_b16 v[82:83], v13 offset:4352
    ds_read_b64_tr_b16 v[84:85], v14 offset:4096
    ds_read_b64_tr_b16 v[86:87], v14 offset:4352
    s_waitcnt lgkmcnt(10)
    v_mfma_f32_32x32x16_bf16 v[96:111], v[64:67], v[128:131], 0
    ds_read_b64_tr_b16 v[88:89], v15 offset:4096
    ds_read_b64_tr_b16 v[90:91], v15 offset:4352
    s_waitcnt lgkmcnt(10)
    v_mfma_f32_32x32x16_bf16 v[96:111], v[68:71], v[132:135], v[96:111]
    v_mov_b32 v128, v20
    v_mov_b32 v129, v20
    v_mov_b32 v130, v20
    ds_read_b64_tr_b16 v[92:93], v16 offset:4096
    ds_read_b64_tr_b16 v[94:95], v16 offset:4352
    s_waitcnt lgkmcnt(10)
    v_mfma_f32_32x32x16_bf16 v[96:111], v[72:75], v[136:139], v[96:111]
    v_mov_b32 v131, v20
    ds_read_b64_tr_b16 v[64:65], v13 offset:8192
    ds_read_b64_tr_b16 v[66:67], v13 offset:8448
    s_waitcnt lgkmcnt(10)
    v_mfma_f32_32x32x16_bf16 v[96:111], v[76:79], v[140:143], v[96:111]
    ds_read_b64_tr_b16 v[68:69], v14 offset:8192
    ds_read_b64_tr_b16 v[70:71], v14 offset:8448
    s_waitcnt lgkmcnt(10)
    v_mfma_f32_32x32x16_bf16 v[96:111], v[80:83], v[144:147], v[96:111]
    ds_read_b64_tr_b16 v[72:73], v15 offset:8192
    ds_read_b64_tr_b16 v[74:75], v15 offset:8448
    s_waitcnt lgkmcnt(10)
    v_mfma_f32_32x32x16_bf16 v[96:111], v[84:87], v[148:151], v[96:111]
    ds_read_b64_tr_b16 v[76:77], v16 offset:8192
    ds_read_b64_tr_b16 v[78:79], v16 offset:8448
    s_waitcnt lgkmcnt(10)
    v_mfma_f32_32x32x16_bf16 v[96:111], v[88:91], v[152:155], v[96:111]
    ds_read_b64_tr_b16 v[80:81], v13 offset:12288
    ds_read_b64_tr_b16 v[82:83], v13 offset:12544
    s_waitcnt lgkmcnt(10)
    v_mfma_f32_32x32x16_bf16 v[96:111], v[92:95], v[156:159], v[96:111]
    ds_read_b64_tr_b16 v[84:85], v14 offset:12288
    ds_read_b64_tr_b16 v[86:87], v14 offset:12544
    s_waitcnt lgkmcnt(10)
    v_mfma_f32_32x32x16_bf16 v[96:111], v[64:67], v[160:163], v[96:111]
    s_waitcnt vmcnt(0)
    s_mov_b64 exec, 1
    s_cmp_eq_u32 s30, 0
    s_cbranch_scc1 Lst_8
    buffer_store_dwordx2 v[22:23], v12, s[12:15], 0 offen
Lsr_9:
    s_mov_b64 exec, -1
    s_mov_b64 exec, 1
    buffer_store_dwordx2 v[22:23], v63, s[12:15], 0 offen sc1
    s_mov_b64 exec, -1
    ds_read_b64_tr_b16 v[88:89], v15 offset:12288
    ds_read_b64_tr_b16 v[90:91], v15 offset:12544
    s_waitcnt lgkmcnt(10)
    v_mfma_f32_32x32x16_bf16 v[96:111], v[68:71], v[164:167], v[96:111]
    s_and_b32 s58, s54, 1
    s_lshl1_add_u32 s58, s53, s58
    s_lshr_b32 s59, s49, 1
    ds_read_b64_tr_b16 v[92:93], v16 offset:12288
    ds_read_b64_tr_b16 v[94:95], v16 offset:12544
    s_waitcnt lgkmcnt(10)
    v_mfma_f32_32x32x16_bf16 v[96:111], v[72:75], v[168:171], v[96:111]
    s_lshl1_add_u32 s44, s58, s59
    s_xor_b32 s59, s59, s49
    s_and_b32 s59, s59, 1
    ds_read_b64_tr_b16 v[64:65], v13 offset:16384
    ds_read_b64_tr_b16 v[66:67], v13 offset:16640
    s_waitcnt lgkmcnt(10)
    v_mfma_f32_32x32x16_bf16 v[96:111], v[76:79], v[172:175], v[96:111]
    s_and_b32 s58, s54, 14
    s_add_u32 s45, s58, s59
    s_mul_i32 s85, s48, 12288
    ds_read_b64_tr_b16 v[68:69], v14 offset:16384
    ds_read_b64_tr_b16 v[70:71], v14 offset:16640
    s_waitcnt lgkmcnt(10)
    v_mfma_f32_32x32x16_bf16 v[96:111], v[80:83], v[176:179], v[96:111]
    s_mul_i32 s87, s48, 176128
    s_mul_i32 s58, s54, 192
    s_add_u32 s87, s87, s58
    ds_read_b64_tr_b16 v[72:73], v15 offset:16384
    ds_read_b64_tr_b16 v[74:75], v15 offset:16640
    s_waitcnt lgkmcnt(10)
    v_mfma_f32_32x32x16_bf16 v[96:111], v[84:87], v[180:183], v[96:111]
    s_movk_i32 s58, 2560
    s_mul_i32 s60, s54, 12
    s_sub_i32 s60, 172, s60
    ds_read_b64_tr_b16 v[76:77], v16 offset:16384
    ds_read_b64_tr_b16 v[78:79], v16 offset:16640
    s_waitcnt lgkmcnt(10)
    v_mfma_f32_32x32x16_bf16 v[96:111], v[88:91], v[184:187], v[96:111]
    v_mov_b32 v12, 1073741824
    v_add_u32 v10, 0, v1
    v_mul_u32_u24 v112, 171, v10
    ds_read_b64_tr_b16 v[80:81], v13 offset:20480
    ds_read_b64_tr_b16 v[82:83], v13 offset:20736
    s_waitcnt lgkmcnt(10)
    v_mfma_f32_32x32x16_bf16 v[96:111], v[92:95], v[188:191], v[96:111]
    v_lshrrev_b32 v112, 11, v112
    v_mul_u32_u24 v11, 12, v112
    v_sub_u32 v11, v10, v11
    ds_read_b64_tr_b16 v[84:85], v14 offset:20480
    ds_read_b64_tr_b16 v[86:87], v14 offset:20736
    s_waitcnt lgkmcnt(10)
    v_mfma_f32_32x32x16_bf16 v[96:111], v[64:67], v[192:195], v[96:111]
    v_cmp_gt_i32 vcc, s60, v11
    v_lshlrev_b32 v10, 4, v10
    v_mad_u32_u24 v112, v112, s58, v10
    ds_read_b64_tr_b16 v[88:89], v15 offset:20480
    ds_read_b64_tr_b16 v[90:91], v15 offset:20736
    s_waitcnt lgkmcnt(10)
    v_mfma_f32_32x32x16_bf16 v[96:111], v[68:71], v[196:199], v[96:111]
    v_cndmask_b32 v112, v12, v112, vcc
    v_add_u32 v10, 64, v1
    v_mul_u32_u24 v113, 171, v10
    ds_read_b64_tr_b16 v[92:93], v16 offset:20480
    ds_read_b64_tr_b16 v[94:95], v16 offset:20736
    s_waitcnt lgkmcnt(10)
    v_mfma_f32_32x32x16_bf16 v[96:111], v[72:75], v[200:203], v[96:111]
    v_lshrrev_b32 v113, 11, v113
    v_mul_u32_u24 v11, 12, v113
    v_sub_u32 v11, v10, v11
    ds_read_b64_tr_b16 v[64:65], v13 offset:24576
    ds_read_b64_tr_b16 v[66:67], v13 offset:24832
    s_waitcnt lgkmcnt(10)
    v_mfma_f32_32x32x16_bf16 v[96:111], v[76:79], v[204:207], v[96:111]
    v_cmp_gt_i32 vcc, s60, v11
    v_lshlrev_b32 v10, 4, v10
    v_mad_u32_u24 v113, v113, s58, v10
    ds_read_b64_tr_b16 v[68:69], v14 offset:24576
    ds_read_b64_tr_b16 v[70:71], v14 offset:24832
    s_waitcnt lgkmcnt(10)
    v_mfma_f32_32x32x16_bf16 v[96:111], v[80:83], v[208:211], v[96:111]
    v_cndmask_b32 v113, v12, v113, vcc
    v_add_u32 v10, 128, v1
    v_mul_u32_u24 v114, 171, v10
    ds_read_b64_tr_b16 v[72:73], v15 offset:24576
    ds_read_b64_tr_b16 v[74:75], v15 offset:24832
    s_waitcnt lgkmcnt(10)
    v_mfma_f32_32x32x16_bf16 v[96:111], v[84:87], v[212:215], v[96:111]
    v_lshrrev_b32 v114, 11, v114
    v_mul_u32_u24 v11, 12, v114
    v_sub_u32 v11, v10, v11
    ds_read_b64_tr_b16 v[76:77], v16 offset:24576
    ds_read_b64_tr_b16 v[78:79], v16 offset:24832
    s_waitcnt lgkmcnt(10)
    v_mfma_f32_32x32x16_bf16 v[96:111], v[88:91], v[216:219], v[96:111]
    v_cmp_gt_i32 vcc, s60, v11
    v_lshlrev_b32 v10, 4, v10
    v_mad_u32_u24 v114, v114, s58, v10
    ds_read_b64_tr_b16 v[80:81], v13 offset:28672
    ds_read_b64_tr_b16 v[82:83], v13 offset:28928
    s_waitcnt lgkmcnt(10)
    v_mfma_f32_32x32x16_bf16 v[96:111], v[92:95], v[220:223], v[96:111]
    v_cndmask_b32 v114, v12, v114, vcc
    s_lshr_b32 s59, s54, 1
    s_lshl_b32 s63, s59, 12
    ds_read_b64_tr_b16 v[84:85], v14 offset:28672
    ds_read_b64_tr_b16 v[86:87], v14 offset:28928
    s_waitcnt lgkmcnt(10)
    v_mfma_f32_32x32x16_bf16 v[96:111], v[64:67], v[224:227], v[96:111]
    s_add_u32 s63, s63, 294912
    v_bfe_u32 v122, v1, 1, 3
    s_lshl_b32 s58, s49, 10
    ds_read_b64_tr_b16 v[88:89], v15 offset:28672
    ds_read_b64_tr_b16 v[90:91], v15 offset:28928
    s_waitcnt lgkmcnt(10)
    v_mfma_f32_32x32x16_bf16 v[96:111], v[68:71], v[228:231], v[96:111]
    s_add_u32 s58, s58, s63
    v_lshl_add_u32 v122, v122, 7, s58
    s_lshl2_add_u32 s58, s49, 106528
    ds_read_b64_tr_b16 v[92:93], v16 offset:28672
    ds_read_b64_tr_b16 v[94:95], v16 offset:28928
    s_waitcnt lgkmcnt(10)
    v_mfma_f32_32x32x16_bf16 v[96:111], v[72:75], v[232:235], v[96:111]
    v_mov_b32 v121, s58
    v_mov_b32 v123, 106528
    v_and_b32 v10, 16, v3
    ds_read_b128 v[64:67], v61
    s_waitcnt lgkmcnt(9)
    v_mfma_f32_32x32x16_bf16 v[96:111], v[76:79], v[236:239], v[96:111]
    v_add_u32 v122, v122, v10
    s_and_b32 s61, s54, 1
    s_lshl1_add_u32 s61, s53, s61
    s_waitcnt lgkmcnt(7)
    v_mfma_f32_32x32x16_bf16 v[96:111], v[80:83], v[240:243], v[96:111]
    s_lshl_b32 s58, s49, 5
    s_mov_b32 s62, 14680064
    s_mov_b32 s60, 0x158000
    s_waitcnt lgkmcnt(5)
    v_mfma_f32_32x32x16_bf16 v[96:111], v[84:87], v[244:247], v[96:111]
    s_cmp_eq_u32 s49, 3
    s_cselect_b64 s[20:21], s[28:29], s[36:37]
    s_cselect_b32 s22, 0x80000, s60
    s_waitcnt lgkmcnt(3)
    v_mfma_f32_32x32x16_bf16 v[96:111], v[88:91], v[248:251], v[96:111]
    s_cselect_b32 s58, 0, s58
    s_cselect_b32 s88, 32, 86
    s_cselect_b32 s62, 16252928, s62
    s_waitcnt lgkmcnt(1)
    v_mfma_f32_32x32x16_bf16 v[96:111], v[92:95], v[252:255], v[96:111]
    s_add_u32 s58, s61, s58
    s_mul_i32 s60, s59, s88
    s_lshl1_add_u32 s60, s60, s58
    s_waitcnt lgkmcnt(0)
    v_mfma_f32_32x32x16_bf16 v[96:111], v[64:67], v[128:131], v[96:111]
    s_lshl_b32 s60, s60, 10
    s_add_u32 s60, s60, s62
    s_lshl_b32 s88, s88, 10
    s_nop 8
    v_pk_mul_f32 v[64:65], v[96:97], v[20:21] op_sel:[0,1] op_sel_hi:[1,1]
    v_pk_mul_f32 v[66:67], v[98:99], v[20:21] op_sel:[0,1] op_sel_hi:[1,1]
    v_pk_mul_f32 v[68:69], v[100:101], v[20:21] op_sel:[0,1] op_sel_hi:[1,1]
    v_pk_mul_f32 v[70:71], v[102:103], v[20:21] op_sel:[0,1] op_sel_hi:[1,1]
    v_pk_mul_f32 v[72:73], v[104:105], v[20:21] op_sel:[0,1] op_sel_hi:[1,1]
    v_pk_mul_f32 v[74:75], v[106:107], v[20:21] op_sel:[0,1] op_sel_hi:[1,1]
    v_pk_mul_f32 v[76:77], v[108:109], v[20:21] op_sel:[0,1] op_sel_hi:[1,1]
    v_pk_mul_f32 v[78:79], v[110:111], v[20:21] op_sel:[0,1] op_sel_hi:[1,1]
    v_cvt_pk_bf16_f32 v96, v64, v65
    v_cvt_pk_bf16_f32 v97, v66, v67
    v_cvt_pk_bf16_f32 v98, v68, v69
    v_cvt_pk_bf16_f32 v99, v70, v71
    ds_write_b128 v60, v[96:99]
    v_cvt_pk_bf16_f32 v100, v72, v73
    v_cvt_pk_bf16_f32 v101, v74, v75
    v_cvt_pk_bf16_f32 v102, v76, v77
    v_cvt_pk_bf16_f32 v103, v78, v79
    ds_write_b128 v60, v[100:103] offset:4096
    s_cmp_lt_u32 s58, 86
    s_cselect_b32 s60, s60, 1073741824
    v_add_u32 v119, s60, v3
    s_lshl_b32 s58, s58, 14
    s_lshl_b32 s60, s59, 7
    s_add_u32 s58, s58, s60
    v_lshrrev_b32 v10, 2, v1
    v_and_b32 v10, 4, v10
    v_xor_b32 v10, v10, v1
    v_and_b32 v10, 7, v10
    v_lshl_add_u32 v10, v10, 4, s58
    v_lshrrev_b32 v11, 3, v1
    v_lshl_add_u32 v115, v11, 10, v10
    v_add_u32 v116, 0x2000, v115
    v_bfe_u32 v10, v1, 2, 2
    v_lshrrev_b32 v11, 5, v1
    v_lshl_add_u32 v10, v11, 2, v10
    v_lshrrev_b32 v11, 2, v1
    v_and_b32 v11, 4, v11
    v_and_or_b32 v11, v1, 3, v11
    v_lshlrev_b32 v11, 3, v11
    v_bfe_u32 v117, v1, 3, 1
    v_lshl_add_u32 v117, v117, 6, v11
    v_lshl_add_u32 v117, v10, 7, v117
    v_add_u32 v117, s85, v117
    v_xor_b32 v118, 64, v117
    s_lshl4_add_u32 s61, s61, s49
    s_lshl3_add_u32 s58, s61, s63
    v_mov_b32 v120, s58
    s_and_b32 s58, s49, 1
    s_lshl1_add_u32 s58, s45, s58
    s_lshl_b32 s58, s58, 14
    s_add_u32 s86, s58, 16252928
    s_movk_i32 s89, 1024
    s_add_u32 s56, s86, 15360
    s_xor_b32 s58, s58, 0x8000
    s_add_u32 s57, s58, 16268288
    s_mov_b32 s26, 14680064
    s_lshl2_add_u32 s58, s53, s49
    s_mul_i32 s90, s58, 64512
    s_add_u32 s90, s90, 6291456
    s_mul_i32 s91, s44, 64512
    s_add_u32 s91, s91, 6291456
    s_waitcnt lgkmcnt(0)
    s_barrier
    s_setprio 3
    s_xor_b32 s58, s53, 0
    s_lshl_b32 s58, s58, 13
    s_add_u32 s58, s58, s68
    buffer_load_dwordx4 v[24:27], v3, s[12:15], s58 offen sc1
    s_mov_b64 exec, s[40:41]
    buffer_load_dwordx4 v[28:31], v4, s[12:15], s58 offen offset:1024 sc1
    buffer_load_dwordx4 v[32:35], v4, s[12:15], s58 offen offset:1536 sc1
    s_mov_b64 exec, -1
    s_xor_b32 s58, s53, 1
    s_lshl_b32 s58, s58, 13
    s_add_u32 s58, s58, s68
    buffer_load_dwordx4 v[36:39], v3, s[12:15], s58 offen sc1
    s_mov_b64 exec, s[40:41]
    buffer_load_dwordx4 v[40:43], v4, s[12:15], s58 offen offset:1024 sc1
    buffer_load_dwordx4 v[44:47], v4, s[12:15], s58 offen offset:1536 sc1
    s_mov_b64 exec, -1
    s_lshl_b32 s59, s50, 12
    s_add_u32 s59, s59, 98304
    s_add_u32 s58, s49, 1
    s_and_b32 s58, s58, 3
    s_lshl_b32 s58, s58, 10
    s_add_u32 s58, s58, s59
    v_add_u32 v124, s58, v3
    s_add_u32 s58, s49, 2
    s_and_b32 s58, s58, 3
    s_lshl_b32 s58, s58, 10
    s_add_u32 s58, s58, s59
    v_add_u32 v125, s58, v3
    s_add_u32 s58, s49, 3
    s_and_b32 s58, s58, 3
    s_lshl_b32 s58, s58, 10
    s_add_u32 s58, s58, s59
    v_add_u32 v126, s58, v3
    s_add_u32 s58, s49, 4
    s_and_b32 s58, s58, 3
    s_lshl_b32 s58, s58, 10
    s_add_u32 s58, s58, s59
    v_add_u32 v127, s58, v3
    ds_read_b128 v[96:99], v124
    ds_read_b128 v[100:103], v125
    ds_read_b128 v[104:107], v126
    ds_read_b128 v[108:111], v127
    v_mov_b32 v64, 0
    v_mov_b32 v65, 0
    v_mov_b32 v66, 0
    v_mov_b32 v67, 0
    s_nop 1
    v_mfma_f32_32x32x16_bf16 v[128:143], v[64:67], v[64:67], 0
    v_mfma_f32_32x32x16_bf16 v[144:159], v[64:67], v[64:67], 0
    v_mfma_f32_32x32x16_bf16 v[160:175], v[64:67], v[64:67], 0
    v_mfma_f32_32x32x16_bf16 v[176:191], v[64:67], v[64:67], 0
    s_waitcnt lgkmcnt(0)
    s_add_u32 s58, s84, 2
    s_and_b32 s58, s58, 15
    s_lshl_b32 s58, s58, 7
    s_add_u32 s58, s58, s100
    s_load_dwordx2 s[92:93], s[12:13], s58 glc
    s_add_u32 s58, s58, 0x800
    s_load_dwordx2 s[94:95], s[12:13], s58 glc
    s_add_u32 s58, s84, 3
    s_and_b32 s58, s58, 15
    s_lshl_b32 s58, s58, 7
    s_add_u32 s58, s58, s100
    s_load_dwordx2 s[96:97], s[12:13], s58 glc
    s_add_u32 s58, s58, 0x800
    s_load_dwordx2 s[98:99], s[12:13], s58 glc
    v_lshrrev_b32 v60, 5, v1
    v_lshlrev_b32 v60, 3, v60
    v_and_b32 v61, 31, v1
    s_lshl_b32 s58, s45, 6
    v_lshl_add_u32 v60, v61, 10, v60
    s_lshl_b32 s59, s44, 15
    s_add_u32 s58, s58, s59
    buffer_load_dwordx2 v[16:17], v60, s[4:7], s58 offen offset:0
    buffer_load_dwordx2 v[18:19], v60, s[4:7], s58 offen offset:16
    buffer_load_dwordx2 v[20:21], v60, s[4:7], s58 offen offset:32
    buffer_load_dwordx2 v[6:7], v60, s[4:7], s58 offen offset:48
    s_mov_b64 s[8:9], s[32:33]
    s_mov_b32 s10, 1409024
    s_mov_b32 s11, 0x20000
    v_lshlrev_b32 v14, 7, v1
    s_mul_i32 s59, s50, 27648
    s_add_u32 s59, s59, 108544
    s_add_u32 s58, s49, 1
    s_and_b32 s58, s58, 3
    s_mul_i32 s58, s58, 6912
    s_add_u32 s58, s58, s59
    s_add_u32 s58, s58, 0
    v_add_u32 v10, s58, v3
    s_add_u32 s58, s49, 2
    s_and_b32 s58, s58, 3
    s_mul_i32 s58, s58, 6912
    s_add_u32 s58, s58, s59
    s_add_u32 s58, s58, 2304
    v_add_u32 v11, s58, v3
    s_add_u32 s58, s49, 3
    s_and_b32 s58, s58, 3
    s_mul_i32 s58, s58, 6912
    s_add_u32 s58, s58, s59
    s_add_u32 s58, s58, 4608
    v_add_u32 v12, s58, v3
    s_mul_i32 s58, s49, 6912
    s_add_u32 s58, s58, s59
    v_add_u32 v13, s58, v3
    v_mul_u32_u24 v15, 12, v1
    s_waitcnt vmcnt(7)
    s_branch L_attn
L_f1_tail:
    s_setprio 0
    s_and_b32 s58, s54, 1
    s_lshl1_add_u32 s58, s53, s58
    s_lshr_b32 s59, s49, 1
    s_lshl1_add_u32 s44, s58, s59
    s_and_b32 s59, s49, 1
    s_and_b32 s58, s54, 14
    s_add_u32 s45, s58, s59
    v_lshrrev_b32 v108, 5, v1
    v_lshlrev_b32 v108, 3, v108
    v_and_b32 v109, 31, v1
    s_lshl_b32 s58, s45, 6
    s_mov_b64 s[4:5], s[38:39]
    s_mov_b32 s6, 1024
    s_mov_b32 s7, 0x20000
    buffer_load_dwordx2 v[16:17], v108, s[4:7], s58 offen offset:0
    buffer_load_dwordx2 v[18:19], v108, s[4:7], s58 offen offset:16
    buffer_load_dwordx2 v[20:21], v108, s[4:7], s58 offen offset:32
    buffer_load_dwordx2 v[6:7], v108, s[4:7], s58 offen offset:48
    s_mov_b64 s[20:21], s[34:35]
    s_mov_b32 s22, 2752
    s_mov_b32 s23, 0x20000
    s_mul_i32 s58, s54, 3
    s_add_u32 s58, s58, s49
    s_lshl_b32 s58, s58, 6
    v_lshl_add_u32 v108, v109, 1, s58
    buffer_load_ushort v0, v108, s[20:23], 0 offen
    s_mov_b64 s[8:9], s[32:33]
    s_mov_b32 s10, 1409024
    s_mov_b32 s11, 0x20000
    s_mul_i32 s85, s48, 12288
    s_mul_i32 s87, s48, 176128
    s_mul_i32 s58, s54, 192
    s_add_u32 s87, s87, s58
    s_movk_i32 s58, 2560
    s_mul_i32 s60, s54, 12
    s_sub_i32 s60, 172, s60
    v_mov_b32 v12, 1073741824
    v_add_u32 v10, 0, v1
    v_mul_u32_u24 v112, 171, v10
    v_lshrrev_b32 v112, 11, v112
    v_mul_u32_u24 v11, 12, v112
    v_sub_u32 v11, v10, v11
    v_cmp_gt_i32 vcc, s60, v11
    v_lshlrev_b32 v10, 4, v10
    v_mad_u32_u24 v112, v112, s58, v10
    v_cndmask_b32 v112, v12, v112, vcc
    v_add_u32 v10, 64, v1
    v_mul_u32_u24 v113, 171, v10
    v_lshrrev_b32 v113, 11, v113
    v_mul_u32_u24 v11, 12, v113
    v_sub_u32 v11, v10, v11
    v_cmp_gt_i32 vcc, s60, v11
    v_lshlrev_b32 v10, 4, v10
    v_mad_u32_u24 v113, v113, s58, v10
    v_cndmask_b32 v113, v12, v113, vcc
    v_add_u32 v10, 128, v1
    v_mul_u32_u24 v114, 171, v10
    v_lshrrev_b32 v114, 11, v114
    v_mul_u32_u24 v11, 12, v114
    v_sub_u32 v11, v10, v11
    v_cmp_gt_i32 vcc, s60, v11
    v_lshlrev_b32 v10, 4, v10
    v_mad_u32_u24 v114, v114, s58, v10
    v_cndmask_b32 v114, v12, v114, vcc
    s_lshr_b32 s59, s54, 1
    s_lshl_b32 s63, s59, 12
    s_add_u32 s63, s63, 294912
    v_bfe_u32 v122, v1, 1, 3
    s_lshl_b32 s58, s49, 10
    s_add_u32 s58, s58, s63
    v_lshl_add_u32 v122, v122, 7, s58
    s_lshl2_add_u32 s58, s49, 106528
    v_mov_b32 v121, s58
    v_mov_b32 v123, 106528
    v_and_b32 v10, 16, v3
    v_add_u32 v122, v122, v10
    v_mov_b32 v115, 1073741824
    v_mov_b32 v116, 1073741824
    v_mov_b32 v119, 1073741824
    v_mov_b32 v120, 1073741824
    v_lshlrev_b32 v117, 3, v1
    v_lshlrev_b32 v118, 3, v1
    s_mov_b32 s88, 0
    s_mul_i32 s58, s45, 86
    s_lshr_b32 s59, s49, 1
    s_add_u32 s58, s58, s59
    s_lshl_b32 s58, s58, 10
    s_add_u32 s26, s58, 14680064
    s_mov_b32 s86, s26
    s_movk_i32 s89, 6144
    s_add_u32 s56, s26, 2048
    s_add_u32 s57, s26, 8192
    s_lshl2_add_u32 s58, s53, s49
    s_mul_i32 s90, s58, 64512
    s_add_u32 s90, s90, 6291456
    s_mul_i32 s91, s44, 64512
    s_add_u32 s91, s91, 6291456
    v_lshlrev_b32 v14, 7, v1
    s_mul_i32 s59, s50, 27648
    s_add_u32 s59, s59, 108544
    s_add_u32 s58, s49, 1
    s_and_b32 s58, s58, 3
    s_mul_i32 s58, s58, 6912
    s_add_u32 s58, s58, s59
    s_add_u32 s58, s58, 0
    v_add_u32 v10, s58, v3
    s_add_u32 s58, s49, 2
    s_and_b32 s58, s58, 3
    s_mul_i32 s58, s58, 6912
    s_add_u32 s58, s58, s59
    s_add_u32 s58, s58, 2304
    v_add_u32 v11, s58, v3
    s_add_u32 s58, s49, 3
    s_and_b32 s58, s58, 3
    s_mul_i32 s58, s58, 6912
    s_add_u32 s58, s58, s59
    s_add_u32 s58, s58, 4608
    v_add_u32 v12, s58, v3
    s_mul_i32 s58, s49, 6912
    s_add_u32 s58, s58, s59
    v_add_u32 v13, s58, v3
    v_mul_u32_u24 v15, 12, v1
    buffer_load_dwordx2 v[8:9], v62, s[12:15], 0 offen sc1
    s_bitcmp1_b32 s52, 0
    s_cselect_b32 s62, 12, 3
    s_branch Lklg_11
Lkl_10:
    buffer_load_dwordx2 v[8:9], v62, s[12:15], 0 offen sc1
Lklg_11:
    s_add_u32 s67, s67, 1
    s_cmp_gt_u32 s67, 0x20000
    s_cselect_b32 s60, 0, s62
    s_waitcnt vmcnt(0)
    v_cmp_ne_u64 vcc, s[46:47], v[8:9]
    s_nop 0
    s_and_b32 s60, s60, vcc_lo
    s_cbranch_scc1 Lkl_10
    s_xor_b32 s58, s53, 0
    s_lshl_b32 s58, s58, 13
    s_add_u32 s58, s58, s68
    buffer_load_dwordx4 v[24:27], v3, s[12:15], s58 offen sc1
    s_mov_b64 exec, s[40:41]
    buffer_load_dwordx4 v[28:31], v4, s[12:15], s58 offen offset:1024 sc1
    buffer_load_dwordx4 v[32:35], v4, s[12:15], s58 offen offset:1536 sc1
    s_mov_b64 exec, -1
    s_cbranch_vccz Lklg_13_x
Lkl_12:
    buffer_load_dwordx2 v[8:9], v62, s[12:15], 0 offen sc1
Lklg_13:
    s_add_u32 s67, s67, 1
    s_cmp_gt_u32 s67, 0x20000
    s_cselect_b32 s60, 0, 15
    s_waitcnt vmcnt(0)
    v_cmp_ne_u64 vcc, s[46:47], v[8:9]
    s_nop 0
    s_and_b32 s60, s60, vcc_lo
    s_cbranch_scc1 Lkl_12
Lklg_13_x:
    s_xor_b32 s58, s53, 1
    s_lshl_b32 s58, s58, 13
    s_add_u32 s58, s58, s68
    buffer_load_dwordx4 v[36:39], v3, s[12:15], s58 offen sc1
    s_mov_b64 exec, s[40:41]
    buffer_load_dwordx4 v[40:43], v4, s[12:15], s58 offen offset:1024 sc1
    buffer_load_dwordx4 v[44:47], v4, s[12:15], s58 offen offset:1536 sc1
    s_mov_b64 exec, -1
    s_barrier
    ds_read_b128 v[96:99], v124
    ds_read_b128 v[100:103], v125
    ds_read_b128 v[104:107], v126
    ds_read_b128 v[108:111], v127
    s_waitcnt lgkmcnt(0)
    s_add_u32 s58, s84, 2
    s_and_b32 s58, s58, 15
    s_lshl_b32 s58, s58, 7
    s_add_u32 s58, s58, s100
    s_load_dwordx2 s[92:93], s[12:13], s58 glc
    s_add_u32 s58, s58, 0x800
    s_load_dwordx2 s[94:95], s[12:13], s58 glc
    s_add_u32 s58, s84, 3
    s_and_b32 s58, s58, 15
    s_lshl_b32 s58, s58, 7
    s_add_u32 s58, s58, s100
    s_load_dwordx2 s[96:97], s[12:13], s58 glc
    s_add_u32 s58, s58, 0x800
    s_load_dwordx2 s[98:99], s[12:13], s58 glc
    s_waitcnt vmcnt(3)
L_attn:
    s_setprio 3
    v_mfma_f32_32x32x16_bf16 v[64:79], v[24:27], v[96:99], 4.0
    s_nop 11
    v_exp_f32 v64, v64
    v_exp_f32 v65, v65
    v_exp_f32 v66, v66
    v_exp_f32 v67, v67
    v_exp_f32 v68, v68
    v_mfma_f32_32x32x16_bf16 v[80:95], v[24:27], v[100:103], 4.0
    v_exp_f32 v69, v69
    v_exp_f32 v70, v70
    v_exp_f32 v71, v71
    v_exp_f32 v72, v72
    v_exp_f32 v73, v73
    v_smfmac_f32_32x32x32_bf16 v[128:143], v[28:31], v[64:71], v2
    v_exp_f32 v74, v74
    v_exp_f32 v75, v75
    v_exp_f32 v76, v76
    v_exp_f32 v77, v77
    v_exp_f32 v78, v78
    v_exp_f32 v79, v79
    v_exp_f32 v80, v80
    v_exp_f32 v81, v81
    v_smfmac_f32_32x32x32_bf16 v[128:143], v[32:35], v[72:79], v2
    v_exp_f32 v82, v82
    v_exp_f32 v83, v83
    v_exp_f32 v84, v84
    v_mfma_f32_32x32x16_bf16 v[64:79], v[24:27], v[104:107], 4.0
    v_exp_f32 v85, v85
    v_exp_f32 v86, v86
    v_exp_f32 v87, v87
    v_exp_f32 v88, v88
    v_exp_f32 v89, v89
    v_smfmac_f32_32x32x32_bf16 v[144:159], v[28:31], v[80:87], v2
    v_exp_f32 v90, v90
    v_exp_f32 v91, v91
    v_exp_f32 v92, v92
    v_exp_f32 v93, v93
    v_exp_f32 v94, v94
    v_exp_f32 v95, v95
    v_exp_f32 v64, v64
    v_exp_f32 v65, v65
    v_smfmac_f32_32x32x32_bf16 v[144:159], v[32:35], v[88:95], v2
    v_exp_f32 v66, v66
    v_exp_f32 v67, v67
    v_exp_f32 v68, v68
    v_mfma_f32_32x32x16_bf16 v[80:95], v[24:27], v[108:111], 4.0
    v_exp_f32 v69, v69
    v_exp_f32 v70, v70
    v_exp_f32 v71, v71
    v_exp_f32 v72, v72
    v_exp_f32 v73, v73
    v_smfmac_f32_32x32x32_bf16 v[160:175], v[28:31], v[64:71], v2
    v_exp_f32 v74, v74
    v_exp_f32 v75, v75
    v_exp_f32 v76, v76
    v_exp_f32 v77, v77
    v_exp_f32 v78, v78
    v_exp_f32 v79, v79
    v_exp_f32 v80, v80
    v_exp_f32 v81, v81
    v_smfmac_f32_32x32x32_bf16 v[160:175], v[32:35], v[72:79], v2
    v_exp_f32 v82, v82
    v_exp_f32 v83, v83
    v_exp_f32 v84, v84
    s_waitcnt vmcnt(0)
    v_mfma_f32_32x32x16_bf16 v[64:79], v[36:39], v[96:99], 4.0
    v_exp_f32 v85, v85
    v_exp_f32 v86, v86
    v_exp_f32 v87, v87
    v_exp_f32 v88, v88
    v_exp_f32 v89, v89
    v_smfmac_f32_32x32x32_bf16 v[176:191], v[28:31], v[80:87], v2
    v_exp_f32 v90, v90
    v_exp_f32 v91, v91
    v_exp_f32 v92, v92
    v_exp_f32 v93, v93
    v_exp_f32 v94, v94
    v_exp_f32 v95, v95
    v_exp_f32 v64, v64
    v_exp_f32 v65, v65
    v_smfmac_f32_32x32x32_bf16 v[176:191], v[32:35], v[88:95], v2
    v_exp_f32 v66, v66
    s_waitcnt lgkmcnt(0)
    s_xor_b64 s[92:93], s[92:93], s[46:47]
    s_xor_b64 s[94:95], s[94:95], s[46:47]
    s_xor_b64 s[96:97], s[96:97], s[46:47]
    s_xor_b64 s[98:99], s[98:99], s[46:47]
    s_or_b64 s[92:93], s[92:93], s[94:95]
    s_or_b64 s[96:97], s[96:97], s[98:99]
    s_or_b64 s[92:93], s[92:93], s[96:97]
    s_cbranch_scc1 Lsf_14
Lsfr_15:
    s_add_u32 s58, s84, 2
    s_and_b32 s58, s58, 15
    s_lshl_b32 s58, s58, 13
    s_add_u32 s58, s58, s68
    buffer_load_dwordx4 v[48:51], v3, s[12:15], s58 offen sc1
    s_mov_b64 exec, s[40:41]
    buffer_load_dwordx4 v[52:55], v4, s[12:15], s58 offen offset:1024 sc1
    buffer_load_dwordx4 v[56:59], v4, s[12:15], s58 offen offset:1536 sc1
    s_mov_b64 exec, -1
    s_add_u32 s58, s84, 3
    s_and_b32 s58, s58, 15
    s_lshl_b32 s58, s58, 13
    s_add_u32 s58, s58, s68
    buffer_load_dwordx4 v[24:27], v3, s[12:15], s58 offen sc1
    s_mov_b64 exec, s[40:41]
    buffer_load_dwordx4 v[28:31], v4, s[12:15], s58 offen offset:1024 sc1
    buffer_load_dwordx4 v[32:35], v4, s[12:15], s58 offen offset:1536 sc1
    s_mov_b64 exec, -1
    s_add_u32 s58, s84, 4
    s_and_b32 s58, s58, 15
    s_lshl_b32 s58, s58, 7
    s_add_u32 s58, s58, s100
    s_load_dwordx2 s[92:93], s[12:13], s58 glc
    s_add_u32 s58, s58, 0x800
    s_load_dwordx2 s[94:95], s[12:13], s58 glc
    s_add_u32 s58, s84, 5
    s_and_b32 s58, s58, 15
    s_lshl_b32 s58, s58, 7
    s_add_u32 s58, s58, s100
    s_load_dwordx2 s[96:97], s[12:13], s58 glc
    s_add_u32 s58, s58, 0x800
    s_load_dwordx2 s[98:99], s[12:13], s58 glc
    v_exp_f32 v67, v67
    v_exp_f32 v68, v68
    v_mfma_f32_32x32x16_bf16 v[80:95], v[36:39], v[100:103], 4.0
    v_exp_f32 v69, v69
    v_exp_f32 v70, v70
    v_exp_f32 v71, v71
    v_exp_f32 v72, v72
    v_exp_f32 v73, v73
    v_smfmac_f32_32x32x32_bf16 v[128:143], v[40:43], v[64:71], v2
    v_exp_f32 v74, v74
    v_exp_f32 v75, v75
    v_exp_f32 v76, v76
    v_exp_f32 v77, v77
    v_exp_f32 v78, v78
    v_exp_f32 v79, v79
    v_exp_f32 v80, v80
    v_exp_f32 v81, v81
    v_smfmac_f32_32x32x32_bf16 v[128:143], v[44:47], v[72:79], v2
    v_exp_f32 v82, v82
    s_add_u32 m0, s85, 10240
    s_nop 0
    buffer_load_dwordx4 v115, s[20:23], 0 offen lds
    s_add_u32 m0, s85, 11264
    s_nop 0
    buffer_load_dwordx4 v116, s[20:23], 0 offen lds
    v_exp_f32 v83, v83
    v_exp_f32 v84, v84
    v_mfma_f32_32x32x16_bf16 v[64:79], v[36:39], v[104:107], 4.0
    v_exp_f32 v85, v85
    v_exp_f32 v86, v86
    v_exp_f32 v87, v87
    v_exp_f32 v88, v88
    v_exp_f32 v89, v89
    v_smfmac_f32_32x32x32_bf16 v[144:159], v[40:43], v[80:87], v2
    v_exp_f32 v90, v90
    v_exp_f32 v91, v91
    v_exp_f32 v92, v92
    v_exp_f32 v93, v93
    v_exp_f32 v94, v94
    v_exp_f32 v95, v95
    v_exp_f32 v64, v64
    v_exp_f32 v65, v65
    v_smfmac_f32_32x32x32_bf16 v[144:159], v[44:47], v[88:95], v2
    v_exp_f32 v66, v66
    v_exp_f32 v67, v67
    v_exp_f32 v68, v68
    v_mfma_f32_32x32x16_bf16 v[80:95], v[36:39], v[108:111], 4.0
    v_exp_f32 v69, v69
    v_exp_f32 v70, v70
    v_exp_f32 v71, v71
    v_exp_f32 v72, v72
    v_exp_f32 v73, v73
    v_smfmac_f32_32x32x32_bf16 v[160:175], v[40:43], v[64:71], v2
    v_exp_f32 v74, v74
    v_exp_f32 v75, v75
    v_exp_f32 v76, v76
    v_exp_f32 v77, v77
    v_exp_f32 v78, v78
    v_exp_f32 v79, v79
    v_exp_f32 v80, v80
    v_exp_f32 v81, v81
    v_smfmac_f32_32x32x32_bf16 v[160:175], v[44:47], v[72:79], v2
    v_exp_f32 v82, v82
    v_exp_f32 v83, v83
    v_exp_f32 v84, v84
    s_waitcnt vmcnt(5)
    v_mfma_f32_32x32x16_bf16 v[64:79], v[48:51], v[96:99], 4.0
    v_exp_f32 v85, v85
    v_exp_f32 v86, v86
    v_exp_f32 v87, v87
    v_exp_f32 v88, v88
    v_exp_f32 v89, v89
    v_smfmac_f32_32x32x32_bf16 v[176:191], v[40:43], v[80:87], v2
    v_exp_f32 v90, v90
    v_exp_f32 v91, v91
    v_exp_f32 v92, v92
    v_exp_f32 v93, v93
    v_exp_f32 v94, v94
    v_exp_f32 v95, v95
    v_exp_f32 v64, v64
    v_exp_f32 v65, v65
    v_smfmac_f32_32x32x32_bf16 v[176:191], v[44:47], v[88:95], v2
    v_exp_f32 v66, v66
    s_waitcnt lgkmcnt(0)
    s_xor_b64 s[92:93], s[92:93], s[46:47]
    s_xor_b64 s[94:95], s[94:95], s[46:47]
    s_xor_b64 s[96:97], s[96:97], s[46:47]
    s_xor_b64 s[98:99], s[98:99], s[46:47]
    s_or_b64 s[92:93], s[92:93], s[94:95]
    s_or_b64 s[96:97], s[96:97], s[98:99]
    s_or_b64 s[92:93], s[92:93], s[96:97]
    s_cbranch_scc1 Lsf_16
Lsfr_17:
    s_add_u32 s58, s84, 4
    s_and_b32 s58, s58, 15
    s_lshl_b32 s58, s58, 13
    s_add_u32 s58, s58, s68
    buffer_load_dwordx4 v[36:39], v3, s[12:15], s58 offen sc1
    s_mov_b64 exec, s[40:41]
    buffer_load_dwordx4 v[40:43], v4, s[12:15], s58 offen offset:1024 sc1
    buffer_load_dwordx4 v[44:47], v4, s[12:15], s58 offen offset:1536 sc1
    s_mov_b64 exec, -1
    v_exp_f32 v67, v67
    v_exp_f32 v68, v68
    v_mfma_f32_32x32x16_bf16 v[80:95], v[48:51], v[100:103], 4.0
    v_exp_f32 v69, v69
    v_exp_f32 v70, v70
    v_exp_f32 v71, v71
    v_exp_f32 v72, v72
    v_exp_f32 v73, v73
    v_smfmac_f32_32x32x32_bf16 v[128:143], v[52:55], v[64:71], v2
    v_exp_f32 v74, v74
    v_exp_f32 v75, v75
    v_exp_f32 v76, v76
    v_exp_f32 v77, v77
    v_exp_f32 v78, v78
    v_exp_f32 v79, v79
    v_exp_f32 v80, v80
    v_exp_f32 v81, v81
    v_smfmac_f32_32x32x32_bf16 v[128:143], v[56:59], v[72:79], v2
    v_exp_f32 v82, v82
    s_add_u32 s58, s84, 6
    s_and_b32 s58, s58, 15
    s_lshl_b32 s58, s58, 7
    s_add_u32 s58, s58, s100
    s_load_dwordx2 s[92:93], s[12:13], s58 glc
    s_add_u32 s58, s58, 0x800
    s_load_dwordx2 s[94:95], s[12:13], s58 glc
    s_add_u32 s58, s84, 7
    s_and_b32 s58, s58, 15
    s_lshl_b32 s58, s58, 7
    s_add_u32 s58, s58, s100
    s_load_dwordx2 s[96:97], s[12:13], s58 glc
    s_add_u32 s58, s58, 0x800
    s_load_dwordx2 s[98:99], s[12:13], s58 glc
    v_exp_f32 v83, v83
    v_exp_f32 v84, v84
    v_mfma_f32_32x32x16_bf16 v[64:79], v[48:51], v[104:107], 4.0
    v_exp_f32 v85, v85
    v_exp_f32 v86, v86
    v_exp_f32 v87, v87
    v_exp_f32 v88, v88
    v_exp_f32 v89, v89
    v_smfmac_f32_32x32x32_bf16 v[144:159], v[52:55], v[80:87], v2
    v_exp_f32 v90, v90
    v_exp_f32 v91, v91
    v_exp_f32 v92, v92
    v_exp_f32 v93, v93
    v_exp_f32 v94, v94
    v_exp_f32 v95, v95
    v_exp_f32 v64, v64
    v_exp_f32 v65, v65
    v_smfmac_f32_32x32x32_bf16 v[144:159], v[56:59], v[88:95], v2
    v_exp_f32 v66, v66
    v_exp_f32 v67, v67
    v_exp_f32 v68, v68
    v_mfma_f32_32x32x16_bf16 v[80:95], v[48:51], v[108:111], 4.0
    v_exp_f32 v69, v69
    v_exp_f32 v70, v70
    v_exp_f32 v71, v71
    v_exp_f32 v72, v72
    v_exp_f32 v73, v73
    v_smfmac_f32_32x32x32_bf16 v[160:175], v[52:55], v[64:71], v2
    v_exp_f32 v74, v74
    v_exp_f32 v75, v75
    v_exp_f32 v76, v76
    v_exp_f32 v77, v77
    v_exp_f32 v78, v78
    v_exp_f32 v79, v79
    v_exp_f32 v80, v80
    v_exp_f32 v81, v81
    v_smfmac_f32_32x32x32_bf16 v[160:175], v[56:59], v[72:79], v2
    v_exp_f32 v82, v82
    v_exp_f32 v83, v83
    v_exp_f32 v84, v84
    s_waitcnt vmcnt(5)
    v_mfma_f32_32x32x16_bf16 v[64:79], v[24:27], v[96:99], 4.0
    v_exp_f32 v85, v85
    v_exp_f32 v86, v86
    v_exp_f32 v87, v87
    v_exp_f32 v88, v88
    v_exp_f32 v89, v89
    v_smfmac_f32_32x32x32_bf16 v[176:191], v[52:55], v[80:87], v2
    v_exp_f32 v90, v90
    v_exp_f32 v91, v91
    v_exp_f32 v92, v92
    v_exp_f32 v93, v93
    v_exp_f32 v94, v94
    v_exp_f32 v95, v95
    v_exp_f32 v64, v64
    v_exp_f32 v65, v65
    v_smfmac_f32_32x32x32_bf16 v[176:191], v[56:59], v[88:95], v2
    v_exp_f32 v66, v66
    s_add_u32 s58, s84, 5
    s_and_b32 s58, s58, 15
    s_lshl_b32 s58, s58, 13
    s_add_u32 s58, s58, s68
    buffer_load_dwordx4 v[48:51], v3, s[12:15], s58 offen sc1
    s_mov_b64 exec, s[40:41]
    buffer_load_dwordx4 v[52:55], v4, s[12:15], s58 offen offset:1024 sc1
    buffer_load_dwordx4 v[56:59], v4, s[12:15], s58 offen offset:1536 sc1
    s_mov_b64 exec, -1
    v_exp_f32 v67, v67
    v_exp_f32 v68, v68
    v_mfma_f32_32x32x16_bf16 v[80:95], v[24:27], v[100:103], 4.0
    v_exp_f32 v69, v69
    v_exp_f32 v70, v70
    v_exp_f32 v71, v71
    v_exp_f32 v72, v72
    v_exp_f32 v73, v73
    v_smfmac_f32_32x32x32_bf16 v[128:143], v[28:31], v[64:71], v2
    v_exp_f32 v74, v74
    v_exp_f32 v75, v75
    v_exp_f32 v76, v76
    v_exp_f32 v77, v77
    v_exp_f32 v78, v78
    v_exp_f32 v79, v79
    v_exp_f32 v80, v80
    v_exp_f32 v81, v81
    v_smfmac_f32_32x32x32_bf16 v[128:143], v[32:35], v[72:79], v2
    v_exp_f32 v82, v82
    s_waitcnt vmcnt(6)
    ds_read_b64_tr_b16 v[248:249], v117 offset:10240
    ds_read_b64_tr_b16 v[250:251], v117 offset:11264
    ds_read_b64_tr_b16 v[252:253], v118 offset:10240
    ds_read_b64_tr_b16 v[254:255], v118 offset:11264
    s_add_u32 m0, s85, 0
    s_add_u32 s58, s87, 0
    buffer_load_dwordx4 v112, s[8:11], s58 offen lds
    v_exp_f32 v83, v83
    v_exp_f32 v84, v84
    v_mfma_f32_32x32x16_bf16 v[64:79], v[24:27], v[104:107], 4.0
    v_exp_f32 v85, v85
    v_exp_f32 v86, v86
    v_exp_f32 v87, v87
    v_exp_f32 v88, v88
    v_exp_f32 v89, v89
    v_smfmac_f32_32x32x32_bf16 v[144:159], v[28:31], v[80:87], v2
    v_exp_f32 v90, v90
    v_exp_f32 v91, v91
    v_exp_f32 v92, v92
    v_exp_f32 v93, v93
    v_exp_f32 v94, v94
    v_exp_f32 v95, v95
    v_exp_f32 v64, v64
    v_exp_f32 v65, v65
    v_smfmac_f32_32x32x32_bf16 v[144:159], v[32:35], v[88:95], v2
    v_exp_f32 v66, v66
    s_waitcnt lgkmcnt(0)
    buffer_store_dwordx4 v[248:251], v119, s[12:15], 0 offen sc1
    buffer_store_dwordx4 v[252:255], v119, s[12:15], s88 offen sc1
    v_exp_f32 v67, v67
    v_exp_f32 v68, v68
    v_mfma_f32_32x32x16_bf16 v[80:95], v[24:27], v[108:111], 4.0
    v_exp_f32 v69, v69
    v_exp_f32 v70, v70
    v_exp_f32 v71, v71
    v_exp_f32 v72, v72
    v_exp_f32 v73, v73
    v_smfmac_f32_32x32x32_bf16 v[160:175], v[28:31], v[64:71], v2
    v_exp_f32 v74, v74
    v_exp_f32 v75, v75
    v_exp_f32 v76, v76
    v_exp_f32 v77, v77
    v_exp_f32 v78, v78
    v_exp_f32 v79, v79
    v_exp_f32 v80, v80
    v_exp_f32 v81, v81
    v_smfmac_f32_32x32x32_bf16 v[160:175], v[32:35], v[72:79], v2
    v_exp_f32 v82, v82
    s_add_u32 m0, s85, 1024
    s_add_u32 s58, s87, 0
    buffer_load_dwordx4 v113, s[8:11], s58 offen lds
    v_exp_f32 v83, v83
    v_exp_f32 v84, v84
    s_waitcnt vmcnt(7)
    v_mfma_f32_32x32x16_bf16 v[64:79], v[36:39], v[96:99], 4.0
    v_exp_f32 v85, v85
    v_exp_f32 v86, v86
    v_exp_f32 v87, v87
    v_exp_f32 v88, v88
    v_exp_f32 v89, v89
    v_smfmac_f32_32x32x32_bf16 v[176:191], v[28:31], v[80:87], v2
    v_exp_f32 v90, v90
    v_exp_f32 v91, v91
    v_exp_f32 v92, v92
    v_exp_f32 v93, v93
    v_exp_f32 v94, v94
    v_exp_f32 v95, v95
    v_exp_f32 v64, v64
    v_exp_f32 v65, v65
    v_smfmac_f32_32x32x32_bf16 v[176:191], v[32:35], v[88:95], v2
    v_exp_f32 v66, v66
    s_waitcnt lgkmcnt(0)
    s_xor_b64 s[92:93], s[92:93], s[46:47]
    s_xor_b64 s[94:95], s[94:95], s[46:47]
    s_xor_b64 s[96:97], s[96:97], s[46:47]
    s_xor_b64 s[98:99], s[98:99], s[46:47]
    s_or_b64 s[92:93], s[92:93], s[94:95]
    s_or_b64 s[96:97], s[96:97], s[98:99]
    s_or_b64 s[92:93], s[92:93], s[96:97]
    s_cbranch_scc1 Lsf_18
Lsfr_19:
    s_add_u32 s58, s84, 6
    s_and_b32 s58, s58, 15
    s_lshl_b32 s58, s58, 13
    s_add_u32 s58, s58, s68
    buffer_load_dwordx4 v[24:27], v3, s[12:15], s58 offen sc1
    s_mov_b64 exec, s[40:41]
    buffer_load_dwordx4 v[28:31], v4, s[12:15], s58 offen offset:1024 sc1
    buffer_load_dwordx4 v[32:35], v4, s[12:15], s58 offen offset:1536 sc1
    s_mov_b64 exec, -1
    v_exp_f32 v67, v67
    v_exp_f32 v68, v68
    v_mfma_f32_32x32x16_bf16 v[80:95], v[36:39], v[100:103], 4.0
    v_exp_f32 v69, v69
    v_exp_f32 v70, v70
    v_exp_f32 v71, v71
    v_exp_f32 v72, v72
    v_exp_f32 v73, v73
    v_smfmac_f32_32x32x32_bf16 v[128:143], v[40:43], v[64:71], v2
    v_exp_f32 v74, v74
    v_exp_f32 v75, v75
    v_exp_f32 v76, v76
    v_exp_f32 v77, v77
    v_exp_f32 v78, v78
    v_exp_f32 v79, v79
    v_exp_f32 v80, v80
    v_exp_f32 v81, v81
    v_smfmac_f32_32x32x32_bf16 v[128:143], v[44:47], v[72:79], v2
    v_exp_f32 v82, v82
    s_add_u32 s58, s84, 8
    s_and_b32 s58, s58, 15
    s_lshl_b32 s58, s58, 7
    s_add_u32 s58, s58, s100
    s_load_dwordx2 s[92:93], s[12:13], s58 glc
    s_add_u32 s58, s58, 0x800
    s_load_dwordx2 s[94:95], s[12:13], s58 glc
    s_add_u32 s58, s84, 9
    s_and_b32 s58, s58, 15
    s_lshl_b32 s58, s58, 7
    s_add_u32 s58, s58, s100
    s_load_dwordx2 s[96:97], s[12:13], s58 glc
    s_add_u32 s58, s58, 0x800
    s_load_dwordx2 s[98:99], s[12:13], s58 glc
    s_add_u32 m0, s85, 2048
    s_add_u32 s58, s87, 0
    buffer_load_dwordx4 v114, s[8:11], s58 offen lds
    v_exp_f32 v83, v83
    v_exp_f32 v84, v84
    v_mfma_f32_32x32x16_bf16 v[64:79], v[36:39], v[104:107], 4.0
    v_exp_f32 v85, v85
    v_exp_f32 v86, v86
    v_exp_f32 v87, v87
    v_exp_f32 v88, v88
    v_exp_f32 v89, v89
    v_smfmac_f32_32x32x32_bf16 v[144:159], v[40:43], v[80:87], v2
    v_exp_f32 v90, v90
    v_exp_f32 v91, v91
    v_exp_f32 v92, v92
    v_exp_f32 v93, v93
    v_exp_f32 v94, v94
    v_exp_f32 v95, v95
    v_exp_f32 v64, v64
    v_exp_f32 v65, v65
    v_smfmac_f32_32x32x32_bf16 v[144:159], v[44:47], v[88:95], v2
    v_exp_f32 v66, v66
    v_exp_f32 v67, v67
    v_exp_f32 v68, v68
    v_mfma_f32_32x32x16_bf16 v[80:95], v[36:39], v[108:111], 4.0
    v_exp_f32 v69, v69
    v_exp_f32 v70, v70
    v_exp_f32 v71, v71
    v_exp_f32 v72, v72
    v_exp_f32 v73, v73
    v_smfmac_f32_32x32x32_bf16 v[160:175], v[40:43], v[64:71], v2
    v_exp_f32 v74, v74
    v_exp_f32 v75, v75
    v_exp_f32 v76, v76
    v_exp_f32 v77, v77
    v_exp_f32 v78, v78
    v_exp_f32 v79, v79
    v_exp_f32 v80, v80
    v_exp_f32 v81, v81
    v_smfmac_f32_32x32x32_bf16 v[160:175], v[44:47], v[72:79], v2
    v_exp_f32 v82, v82
    s_add_u32 m0, s85, 3072
    s_add_u32 s58, s87, 44032
    buffer_load_dwordx4 v112, s[8:11], s58 offen lds
    v_exp_f32 v83, v83
    v_exp_f32 v84, v84
    s_waitcnt vmcnt(9)
    v_mfma_f32_32x32x16_bf16 v[64:79], v[48:51], v[96:99], 4.0
    v_exp_f32 v85, v85
    v_exp_f32 v86, v86
    v_exp_f32 v87, v87
    v_exp_f32 v88, v88
    v_exp_f32 v89, v89
    v_smfmac_f32_32x32x32_bf16 v[176:191], v[40:43], v[80:87], v2
    v_exp_f32 v90, v90
    v_exp_f32 v91, v91
    v_exp_f32 v92, v92
    v_exp_f32 v93, v93
    v_exp_f32 v94, v94
    v_exp_f32 v95, v95
    v_exp_f32 v64, v64
    v_exp_f32 v65, v65
    v_smfmac_f32_32x32x32_bf16 v[176:191], v[44:47], v[88:95], v2
    v_exp_f32 v66, v66
    s_add_u32 s58, s84, 7
    s_and_b32 s58, s58, 15
    s_lshl_b32 s58, s58, 13
    s_add_u32 s58, s58, s68
    buffer_load_dwordx4 v[36:39], v3, s[12:15], s58 offen sc1
    s_mov_b64 exec, s[40:41]
    buffer_load_dwordx4 v[40:43], v4, s[12:15], s58 offen offset:1024 sc1
    buffer_load_dwordx4 v[44:47], v4, s[12:15], s58 offen offset:1536 sc1
    s_mov_b64 exec, -1
    v_exp_f32 v67, v67
    v_exp_f32 v68, v68
    v_mfma_f32_32x32x16_bf16 v[80:95], v[48:51], v[100:103], 4.0
    v_exp_f32 v69, v69
    v_exp_f32 v70, v70
    v_exp_f32 v71, v71
    v_exp_f32 v72, v72
    v_exp_f32 v73, v73
    v_smfmac_f32_32x32x32_bf16 v[128:143], v[52:55], v[64:71], v2
    v_exp_f32 v74, v74
    v_exp_f32 v75, v75
    v_exp_f32 v76, v76
    v_exp_f32 v77, v77
    v_exp_f32 v78, v78
    v_exp_f32 v79, v79
    v_exp_f32 v80, v80
    v_exp_f32 v81, v81
    v_smfmac_f32_32x32x32_bf16 v[128:143], v[56:59], v[72:79], v2
    v_exp_f32 v82, v82
    s_waitcnt vmcnt(9)
    s_mov_b64 exec, 1
    buffer_store_dwordx2 v[22:23], v120, s[12:15], 0 offen sc1
    s_mov_b64 exec, -1
    s_add_u32 m0, s85, 4096
    s_add_u32 s58, s87, 44032
    buffer_load_dwordx4 v113, s[8:11], s58 offen lds
    v_exp_f32 v83, v83
    v_exp_f32 v84, v84
    v_mfma_f32_32x32x16_bf16 v[64:79], v[48:51], v[104:107], 4.0
    v_exp_f32 v85, v85
    v_exp_f32 v86, v86
    v_exp_f32 v87, v87
    v_exp_f32 v88, v88
    v_exp_f32 v89, v89
    v_smfmac_f32_32x32x32_bf16 v[144:159], v[52:55], v[80:87], v2
    v_exp_f32 v90, v90
    v_exp_f32 v91, v91
    v_exp_f32 v92, v92
    v_exp_f32 v93, v93
    v_exp_f32 v94, v94
    v_exp_f32 v95, v95
    v_exp_f32 v64, v64
    v_exp_f32 v65, v65
    v_smfmac_f32_32x32x32_bf16 v[144:159], v[56:59], v[88:95], v2
    v_exp_f32 v66, v66
    v_exp_f32 v67, v67
    v_exp_f32 v68, v68
    v_mfma_f32_32x32x16_bf16 v[80:95], v[48:51], v[108:111], 4.0
    v_exp_f32 v69, v69
    v_exp_f32 v70, v70
    v_exp_f32 v71, v71
    v_exp_f32 v72, v72
    v_exp_f32 v73, v73
    v_smfmac_f32_32x32x32_bf16 v[160:175], v[52:55], v[64:71], v2
    v_exp_f32 v74, v74
    v_exp_f32 v75, v75
    v_exp_f32 v76, v76
    v_exp_f32 v77, v77
    v_exp_f32 v78, v78
    v_exp_f32 v79, v79
    v_exp_f32 v80, v80
    v_exp_f32 v81, v81
    v_smfmac_f32_32x32x32_bf16 v[160:175], v[56:59], v[72:79], v2
    v_exp_f32 v82, v82
    s_add_u32 m0, s85, 5120
    s_add_u32 s58, s87, 44032
    buffer_load_dwordx4 v114, s[8:11], s58 offen lds
    v_exp_f32 v83, v83
    v_exp_f32 v84, v84
    s_waitcnt vmcnt(8)
    v_mfma_f32_32x32x16_bf16 v[64:79], v[24:27], v[96:99], 4.0
    v_exp_f32 v85, v85
    v_exp_f32 v86, v86
    v_exp_f32 v87, v87
    v_exp_f32 v88, v88
    v_exp_f32 v89, v89
    v_smfmac_f32_32x32x32_bf16 v[176:191], v[52:55], v[80:87], v2
    v_exp_f32 v90, v90
    v_exp_f32 v91, v91
    v_exp_f32 v92, v92
    v_exp_f32 v93, v93
    v_exp_f32 v94, v94
    v_exp_f32 v95, v95
    v_exp_f32 v64, v64
    v_exp_f32 v65, v65
    v_smfmac_f32_32x32x32_bf16 v[176:191], v[56:59], v[88:95], v2
    v_exp_f32 v66, v66
    s_waitcnt lgkmcnt(0)
    s_xor_b64 s[92:93], s[92:93], s[46:47]
    s_xor_b64 s[94:95], s[94:95], s[46:47]
    s_xor_b64 s[96:97], s[96:97], s[46:47]
    s_xor_b64 s[98:99], s[98:99], s[46:47]
    s_or_b64 s[92:93], s[92:93], s[94:95]
    s_or_b64 s[96:97], s[96:97], s[98:99]
    s_or_b64 s[92:93], s[92:93], s[96:97]
    s_cbranch_scc1 Lsf_20
Lsfr_21:
    s_add_u32 s58, s84, 8
    s_and_b32 s58, s58, 15
    s_lshl_b32 s58, s58, 13
    s_add_u32 s58, s58, s68
    buffer_load_dwordx4 v[48:51], v3, s[12:15], s58 offen sc1
    s_mov_b64 exec, s[40:41]
    buffer_load_dwordx4 v[52:55], v4, s[12:15], s58 offen offset:1024 sc1
    buffer_load_dwordx4 v[56:59], v4, s[12:15], s58 offen offset:1536 sc1
    s_mov_b64 exec, -1
    v_exp_f32 v67, v67
    v_exp_f32 v68, v68
    v_mfma_f32_32x32x16_bf16 v[80:95], v[24:27], v[100:103], 4.0
    v_exp_f32 v69, v69
    v_exp_f32 v70, v70
    v_exp_f32 v71, v71
    v_exp_f32 v72, v72
    v_exp_f32 v73, v73
    v_smfmac_f32_32x32x32_bf16 v[128:143], v[28:31], v[64:71], v2
    v_exp_f32 v74, v74
    v_exp_f32 v75, v75
    v_exp_f32 v76, v76
    v_exp_f32 v77, v77
    v_exp_f32 v78, v78
    v_exp_f32 v79, v79
    v_exp_f32 v80, v80
    v_exp_f32 v81, v81
    v_smfmac_f32_32x32x32_bf16 v[128:143], v[32:35], v[72:79], v2
    v_exp_f32 v82, v82
    s_add_u32 s58, s84, 10
    s_and_b32 s58, s58, 15
    s_lshl_b32 s58, s58, 7
    s_add_u32 s58, s58, s100
    s_load_dwordx2 s[92:93], s[12:13], s58 glc
    s_add_u32 s58, s58, 0x800
    s_load_dwordx2 s[94:95], s[12:13], s58 glc
    s_add_u32 s58, s84, 11
    s_and_b32 s58, s58, 15
    s_lshl_b32 s58, s58, 7
    s_add_u32 s58, s58, s100
    s_load_dwordx2 s[96:97], s[12:13], s58 glc
    s_add_u32 s58, s58, 0x800
    s_load_dwordx2 s[98:99], s[12:13], s58 glc
    s_add_u32 m0, s85, 6144
    s_add_u32 s58, s87, 88064
    buffer_load_dwordx4 v112, s[8:11], s58 offen lds
    v_exp_f32 v83, v83
    v_exp_f32 v84, v84
    v_mfma_f32_32x32x16_bf16 v[64:79], v[24:27], v[104:107], 4.0
    v_exp_f32 v85, v85
    v_exp_f32 v86, v86
    v_exp_f32 v87, v87
    v_exp_f32 v88, v88
    v_exp_f32 v89, v89
    v_smfmac_f32_32x32x32_bf16 v[144:159], v[28:31], v[80:87], v2
    v_exp_f32 v90, v90
    v_exp_f32 v91, v91
    v_exp_f32 v92, v92
    v_exp_f32 v93, v93
    v_exp_f32 v94, v94
    v_exp_f32 v95, v95
    v_exp_f32 v64, v64
    v_exp_f32 v65, v65
    v_smfmac_f32_32x32x32_bf16 v[144:159], v[32:35], v[88:95], v2
    v_exp_f32 v66, v66
    v_exp_f32 v67, v67
    v_exp_f32 v68, v68
    v_mfma_f32_32x32x16_bf16 v[80:95], v[24:27], v[108:111], 4.0
    v_exp_f32 v69, v69
    v_exp_f32 v70, v70
    v_exp_f32 v71, v71
    v_exp_f32 v72, v72
    v_exp_f32 v73, v73
    v_smfmac_f32_32x32x32_bf16 v[160:175], v[28:31], v[64:71], v2
    v_exp_f32 v74, v74
    v_exp_f32 v75, v75
    v_exp_f32 v76, v76
    v_exp_f32 v77, v77
    v_exp_f32 v78, v78
    v_exp_f32 v79, v79
    v_exp_f32 v80, v80
    v_exp_f32 v81, v81
    v_smfmac_f32_32x32x32_bf16 v[160:175], v[32:35], v[72:79], v2
    v_exp_f32 v82, v82
    s_add_u32 m0, s85, 7168
    s_add_u32 s58, s87, 88064
    buffer_load_dwordx4 v113, s[8:11], s58 offen lds
    v_exp_f32 v83, v83
    v_exp_f32 v84, v84
    s_waitcnt vmcnt(8)
    v_mfma_f32_32x32x16_bf16 v[64:79], v[36:39], v[96:99], 4.0
    v_exp_f32 v85, v85
    v_exp_f32 v86, v86
    v_exp_f32 v87, v87
    v_exp_f32 v88, v88
    v_exp_f32 v89, v89
    v_smfmac_f32_32x32x32_bf16 v[176:191], v[28:31], v[80:87], v2
    v_exp_f32 v90, v90
    v_exp_f32 v91, v91
    v_exp_f32 v92, v92
    v_exp_f32 v93, v93
    v_exp_f32 v94, v94
    v_exp_f32 v95, v95
    v_exp_f32 v64, v64
    v_exp_f32 v65, v65
    v_smfmac_f32_32x32x32_bf16 v[176:191], v[32:35], v[88:95], v2
    v_exp_f32 v66, v66
    s_add_u32 s58, s84, 9
    s_and_b32 s58, s58, 15
    s_lshl_b32 s58, s58, 13
    s_add_u32 s58, s58, s68
    buffer_load_dwordx4 v[24:27], v3, s[12:15], s58 offen sc1
    s_mov_b64 exec, s[40:41]
    buffer_load_dwordx4 v[28:31], v4, s[12:15], s58 offen offset:1024 sc1
    buffer_load_dwordx4 v[32:35], v4, s[12:15], s58 offen offset:1536 sc1
    s_mov_b64 exec, -1
    v_exp_f32 v67, v67
    v_exp_f32 v68, v68
    v_mfma_f32_32x32x16_bf16 v[80:95], v[36:39], v[100:103], 4.0
    v_exp_f32 v69, v69
    v_exp_f32 v70, v70
    v_exp_f32 v71, v71
    v_exp_f32 v72, v72
    v_exp_f32 v73, v73
    v_smfmac_f32_32x32x32_bf16 v[128:143], v[40:43], v[64:71], v2
    v_exp_f32 v74, v74
    v_exp_f32 v75, v75
    v_exp_f32 v76, v76
    v_exp_f32 v77, v77
    v_exp_f32 v78, v78
    v_exp_f32 v79, v79
    v_exp_f32 v80, v80
    v_exp_f32 v81, v81
    v_smfmac_f32_32x32x32_bf16 v[128:143], v[44:47], v[72:79], v2
    v_exp_f32 v82, v82
    s_add_u32 m0, s85, 8192
    s_add_u32 s58, s87, 88064
    buffer_load_dwordx4 v114, s[8:11], s58 offen lds
    v_exp_f32 v83, v83
    v_exp_f32 v84, v84
    v_mfma_f32_32x32x16_bf16 v[64:79], v[36:39], v[104:107], 4.0
    v_exp_f32 v85, v85
    v_exp_f32 v86, v86
    v_exp_f32 v87, v87
    v_exp_f32 v88, v88
    v_exp_f32 v89, v89
    v_smfmac_f32_32x32x32_bf16 v[144:159], v[40:43], v[80:87], v2
    v_exp_f32 v90, v90
    v_exp_f32 v91, v91
    v_exp_f32 v92, v92
    v_exp_f32 v93, v93
    v_exp_f32 v94, v94
    v_exp_f32 v95, v95
    v_exp_f32 v64, v64
    v_exp_f32 v65, v65
    v_smfmac_f32_32x32x32_bf16 v[144:159], v[44:47], v[88:95], v2
    v_exp_f32 v66, v66
    v_exp_f32 v67, v67
    v_exp_f32 v68, v68
    v_mfma_f32_32x32x16_bf16 v[80:95], v[36:39], v[108:111], 4.0
    v_exp_f32 v69, v69
    v_exp_f32 v70, v70
    v_exp_f32 v71, v71
    v_exp_f32 v72, v72
    v_exp_f32 v73, v73
    v_smfmac_f32_32x32x32_bf16 v[160:175], v[40:43], v[64:71], v2
    v_exp_f32 v74, v74
    v_exp_f32 v75, v75
    v_exp_f32 v76, v76
    v_exp_f32 v77, v77
    v_exp_f32 v78, v78
    v_exp_f32 v79, v79
    v_exp_f32 v80, v80
    v_exp_f32 v81, v81
    v_smfmac_f32_32x32x32_bf16 v[160:175], v[44:47], v[72:79], v2
    v_exp_f32 v82, v82
    s_add_u32 m0, s85, 9216
    s_add_u32 s58, s87, 132096
    buffer_load_dwordx4 v112, s[8:11], s58 offen lds
    v_exp_f32 v83, v83
    v_exp_f32 v84, v84
    s_waitcnt vmcnt(7)
    v_mfma_f32_32x32x16_bf16 v[64:79], v[48:51], v[96:99], 4.0
    v_exp_f32 v85, v85
    v_exp_f32 v86, v86
    v_exp_f32 v87, v87
    v_exp_f32 v88, v88
    v_exp_f32 v89, v89
    v_smfmac_f32_32x32x32_bf16 v[176:191], v[40:43], v[80:87], v2
    v_exp_f32 v90, v90
    v_exp_f32 v91, v91
    v_exp_f32 v92, v92
    v_exp_f32 v93, v93
    v_exp_f32 v94, v94
    v_exp_f32 v95, v95
    v_exp_f32 v64, v64
    v_exp_f32 v65, v65
    v_smfmac_f32_32x32x32_bf16 v[176:191], v[44:47], v[88:95], v2
    v_exp_f32 v66, v66
    s_waitcnt lgkmcnt(0)
    s_xor_b64 s[92:93], s[92:93], s[46:47]
    s_xor_b64 s[94:95], s[94:95], s[46:47]
    s_xor_b64 s[96:97], s[96:97], s[46:47]
    s_xor_b64 s[98:99], s[98:99], s[46:47]
    s_or_b64 s[92:93], s[92:93], s[94:95]
    s_or_b64 s[96:97], s[96:97], s[98:99]
    s_or_b64 s[92:93], s[92:93], s[96:97]
    s_cbranch_scc1 Lsf_22
Lsfr_23:
    s_add_u32 s58, s84, 10
    s_and_b32 s58, s58, 15
    s_lshl_b32 s58, s58, 13
    s_add_u32 s58, s58, s68
    buffer_load_dwordx4 v[36:39], v3, s[12:15], s58 offen sc1
    s_mov_b64 exec, s[40:41]
    buffer_load_dwordx4 v[40:43], v4, s[12:15], s58 offen offset:1024 sc1
    buffer_load_dwordx4 v[44:47], v4, s[12:15], s58 offen offset:1536 sc1
    s_mov_b64 exec, -1
    v_exp_f32 v67, v67
    v_exp_f32 v68, v68
    v_mfma_f32_32x32x16_bf16 v[80:95], v[48:51], v[100:103], 4.0
    v_exp_f32 v69, v69
    v_exp_f32 v70, v70
    v_exp_f32 v71, v71
    v_exp_f32 v72, v72
    v_exp_f32 v73, v73
    v_smfmac_f32_32x32x32_bf16 v[128:143], v[52:55], v[64:71], v2
    v_exp_f32 v74, v74
    v_exp_f32 v75, v75
    v_exp_f32 v76, v76
    v_exp_f32 v77, v77
    v_exp_f32 v78, v78
    v_exp_f32 v79, v79
    s_setprio 2
    v_exp_f32 v80, v80
    v_exp_f32 v81, v81
    v_smfmac_f32_32x32x32_bf16 v[128:143], v[56:59], v[72:79], v2
    v_exp_f32 v82, v82
    s_add_u32 s58, s84, 12
    s_and_b32 s58, s58, 15
    s_lshl_b32 s58, s58, 7
    s_add_u32 s58, s58, s100
    s_load_dwordx2 s[92:93], s[12:13], s58 glc
    s_add_u32 s58, s58, 0x800
    s_load_dwordx2 s[94:95], s[12:13], s58 glc
    s_add_u32 s58, s84, 13
    s_and_b32 s58, s58, 15
    s_lshl_b32 s58, s58, 7
    s_add_u32 s58, s58, s100
    s_load_dwordx2 s[96:97], s[12:13], s58 glc
    s_add_u32 s58, s58, 0x800
    s_load_dwordx2 s[98:99], s[12:13], s58 glc
    s_add_u32 m0, s85, 10240
    s_add_u32 s58, s87, 132096
    buffer_load_dwordx4 v113, s[8:11], s58 offen lds
    v_exp_f32 v83, v83
    v_exp_f32 v84, v84
    v_mfma_f32_32x32x16_bf16 v[64:79], v[48:51], v[104:107], 4.0
    v_exp_f32 v85, v85
    v_exp_f32 v86, v86
    v_exp_f32 v87, v87
    v_exp_f32 v88, v88
    v_exp_f32 v89, v89
    v_smfmac_f32_32x32x32_bf16 v[144:159], v[52:55], v[80:87], v2
    v_exp_f32 v90, v90
    v_exp_f32 v91, v91
    v_exp_f32 v92, v92
    v_exp_f32 v93, v93
    v_exp_f32 v94, v94
    v_exp_f32 v95, v95
    v_exp_f32 v64, v64
    v_exp_f32 v65, v65
    v_smfmac_f32_32x32x32_bf16 v[144:159], v[56:59], v[88:95], v2
    v_exp_f32 v66, v66
    buffer_load_dwordx4 v[124:127], v122, s[12:15], 0 offen sc1
    v_exp_f32 v67, v67
    v_exp_f32 v68, v68
    v_mfma_f32_32x32x16_bf16 v[80:95], v[48:51], v[108:111], 4.0
    v_exp_f32 v69, v69
    v_exp_f32 v70, v70
    v_exp_f32 v71, v71
    v_exp_f32 v72, v72
    v_exp_f32 v73, v73
    v_smfmac_f32_32x32x32_bf16 v[160:175], v[52:55], v[64:71], v2
    v_exp_f32 v74, v74
    v_exp_f32 v75, v75
    v_exp_f32 v76, v76
    v_exp_f32 v77, v77
    v_exp_f32 v78, v78
    v_exp_f32 v79, v79
    v_exp_f32 v80, v80
    v_exp_f32 v81, v81
    v_smfmac_f32_32x32x32_bf16 v[160:175], v[56:59], v[72:79], v2
    v_exp_f32 v82, v82
    s_add_u32 m0, s85, 11264
    s_add_u32 s58, s87, 132096
    buffer_load_dwordx4 v114, s[8:11], s58 offen lds
    v_exp_f32 v83, v83
    v_exp_f32 v84, v84
    s_waitcnt vmcnt(8)
    v_mfma_f32_32x32x16_bf16 v[64:79], v[24:27], v[96:99], 4.0
    v_exp_f32 v85, v85
    v_exp_f32 v86, v86
    v_exp_f32 v87, v87
    v_exp_f32 v88, v88
    v_exp_f32 v89, v89
    v_smfmac_f32_32x32x32_bf16 v[176:191], v[52:55], v[80:87], v2
    v_exp_f32 v90, v90
    v_exp_f32 v91, v91
    v_exp_f32 v92, v92
    v_exp_f32 v93, v93
    v_exp_f32 v94, v94
    v_exp_f32 v95, v95
    v_exp_f32 v64, v64
    v_exp_f32 v65, v65
    v_smfmac_f32_32x32x32_bf16 v[176:191], v[56:59], v[88:95], v2
    v_exp_f32 v66, v66
    s_add_u32 s58, s84, 11
    s_and_b32 s58, s58, 15
    s_lshl_b32 s58, s58, 13
    s_add_u32 s58, s58, s68
    buffer_load_dwordx4 v[48:51], v3, s[12:15], s58 offen sc1
    s_mov_b64 exec, s[40:41]
    buffer_load_dwordx4 v[52:55], v4, s[12:15], s58 offen offset:1024 sc1
    buffer_load_dwordx4 v[56:59], v4, s[12:15], s58 offen offset:1536 sc1
    s_mov_b64 exec, -1
    v_exp_f32 v67, v67
    v_exp_f32 v68, v68
    v_mfma_f32_32x32x16_bf16 v[80:95], v[24:27], v[100:103], 4.0
    v_exp_f32 v69, v69
    v_exp_f32 v70, v70
    v_exp_f32 v71, v71
    v_exp_f32 v72, v72
    v_exp_f32 v73, v73
    v_smfmac_f32_32x32x32_bf16 v[128:143], v[28:31], v[64:71], v2
    v_exp_f32 v74, v74
    v_exp_f32 v75, v75
    v_exp_f32 v76, v76
    v_exp_f32 v77, v77
    v_exp_f32 v78, v78
    v_exp_f32 v79, v79
    v_exp_f32 v80, v80
    v_exp_f32 v81, v81
    v_smfmac_f32_32x32x32_bf16 v[128:143], v[32:35], v[72:79], v2
    v_exp_f32 v82, v82
    s_waitcnt vmcnt(4)
    v_cmp_ne_u64 vcc, s[46:47], v[124:125]
    s_nop 0
    s_mov_b64 s[60:61], vcc
    v_cmp_ne_u64 vcc, s[46:47], v[126:127]
    s_nop 0
    s_or_b64 s[60:61], s[60:61], vcc
    s_cbranch_scc1 L_pk_stub
L_pk_ret:
    v_mov_b32 v124, 1
    ds_write_b32 v121, v124
    s_cmp_eq_u32 s50, 0
    s_cselect_b64 s[62:63], 1, -1
    v_exp_f32 v83, v83
    v_exp_f32 v84, v84
    v_mfma_f32_32x32x16_bf16 v[64:79], v[24:27], v[104:107], 4.0
    v_exp_f32 v85, v85
    v_exp_f32 v86, v86
    v_exp_f32 v87, v87
    v_exp_f32 v88, v88
    v_exp_f32 v89, v89
    v_smfmac_f32_32x32x32_bf16 v[144:159], v[28:31], v[80:87], v2
    v_exp_f32 v90, v90
    v_exp_f32 v91, v91
    v_exp_f32 v92, v92
    v_exp_f32 v93, v93
    v_exp_f32 v94, v94
    v_exp_f32 v95, v95
    v_exp_f32 v64, v64
    v_exp_f32 v65, v65
    v_smfmac_f32_32x32x32_bf16 v[144:159], v[32:35], v[88:95], v2
    v_exp_f32 v66, v66
    v_exp_f32 v67, v67
    v_exp_f32 v68, v68
    v_mfma_f32_32x32x16_bf16 v[80:95], v[24:27], v[108:111], 4.0
    v_exp_f32 v69, v69
    v_exp_f32 v70, v70
    v_exp_f32 v71, v71
    v_exp_f32 v72, v72
    v_exp_f32 v73, v73
    v_smfmac_f32_32x32x32_bf16 v[160:175], v[28:31], v[64:71], v2
    v_exp_f32 v74, v74
    v_exp_f32 v75, v75
    v_exp_f32 v76, v76
    v_exp_f32 v77, v77
    v_exp_f32 v78, v78
    v_exp_f32 v79, v79
    v_exp_f32 v80, v80
    v_exp_f32 v81, v81
    v_smfmac_f32_32x32x32_bf16 v[160:175], v[32:35], v[72:79], v2
    v_exp_f32 v82, v82
    ds_read_b128 v[124:127], v123
    v_exp_f32 v83, v83
    v_exp_f32 v84, v84
    s_waitcnt vmcnt(6)
    v_mfma_f32_32x32x16_bf16 v[64:79], v[36:39], v[96:99], 4.0
    v_exp_f32 v85, v85
    v_exp_f32 v86, v86
    v_exp_f32 v87, v87
    v_exp_f32 v88, v88
    v_exp_f32 v89, v89
    v_smfmac_f32_32x32x32_bf16 v[176:191], v[28:31], v[80:87], v2
    v_exp_f32 v90, v90
    v_exp_f32 v91, v91
    v_exp_f32 v92, v92
    v_exp_f32 v93, v93
    v_exp_f32 v94, v94
    v_exp_f32 v95, v95
    v_exp_f32 v64, v64
    v_exp_f32 v65, v65
    v_smfmac_f32_32x32x32_bf16 v[176:191], v[32:35], v[88:95], v2
    v_exp_f32 v66, v66
    s_waitcnt lgkmcnt(0)
    s_xor_b64 s[92:93], s[92:93], s[46:47]
    s_xor_b64 s[94:95], s[94:95], s[46:47]
    s_xor_b64 s[96:97], s[96:97], s[46:47]
    s_xor_b64 s[98:99], s[98:99], s[46:47]
    s_or_b64 s[92:93], s[92:93], s[94:95]
    s_or_b64 s[96:97], s[96:97], s[98:99]
    s_or_b64 s[92:93], s[92:93], s[96:97]
    s_cbranch_scc1 Lsf_24
Lsfr_25:
    s_add_u32 s58, s84, 12
    s_and_b32 s58, s58, 15
    s_lshl_b32 s58, s58, 13
    s_add_u32 s58, s58, s68
    buffer_load_dwordx4 v[24:27], v3, s[12:15], s58 offen sc1
    s_mov_b64 exec, s[40:41]
    buffer_load_dwordx4 v[28:31], v4, s[12:15], s58 offen offset:1024 sc1
    buffer_load_dwordx4 v[32:35], v4, s[12:15], s58 offen offset:1536 sc1
    s_mov_b64 exec, -1
    s_waitcnt lgkmcnt(0)
    v_and_b32 v124, v124, v125
    v_and_b32 v126, v126, v127
    v_and_b32 v124, v124, v126
    v_cmp_ne_u32 vcc, 1, v124
    s_cbranch_vccnz L_fg_stub
L_fg_ret:
    buffer_load_dwordx4 v[192:195], v3, s[12:15], s86 offen sc1
    s_add_u32 s86, s86, s89
    v_exp_f32 v67, v67
    v_exp_f32 v68, v68
    v_mfma_f32_32x32x16_bf16 v[80:95], v[36:39], v[100:103], 4.0
    v_exp_f32 v69, v69
    v_exp_f32 v70, v70
    v_exp_f32 v71, v71
    v_exp_f32 v72, v72
    v_exp_f32 v73, v73
    v_smfmac_f32_32x32x32_bf16 v[128:143], v[40:43], v[64:71], v2
    v_exp_f32 v74, v74
    v_exp_f32 v75, v75
    v_exp_f32 v76, v76
    v_exp_f32 v77, v77
    v_exp_f32 v78, v78
    v_exp_f32 v79, v79
    v_exp_f32 v80, v80
    v_exp_f32 v81, v81
    v_smfmac_f32_32x32x32_bf16 v[128:143], v[44:47], v[72:79], v2
    v_exp_f32 v82, v82
    s_add_u32 s58, s84, 14
    s_and_b32 s58, s58, 15
    s_lshl_b32 s58, s58, 7
    s_add_u32 s58, s58, s100
    s_load_dwordx2 s[92:93], s[12:13], s58 glc
    s_add_u32 s58, s58, 0x800
    s_load_dwordx2 s[94:95], s[12:13], s58 glc
    s_add_u32 s58, s84, 15
    s_and_b32 s58, s58, 15
    s_lshl_b32 s58, s58, 7
    s_add_u32 s58, s58, s100
    s_load_dwordx2 s[96:97], s[12:13], s58 glc
    s_add_u32 s58, s58, 0x800
    s_load_dwordx2 s[98:99], s[12:13], s58 glc
    buffer_load_dwordx4 v[196:199], v3, s[12:15], s86 offen sc1
    s_add_u32 s86, s86, s89
    v_exp_f32 v83, v83
    v_exp_f32 v84, v84
    v_mfma_f32_32x32x16_bf16 v[64:79], v[36:39], v[104:107], 4.0
    v_exp_f32 v85, v85
    v_exp_f32 v86, v86
    v_exp_f32 v87, v87
    v_exp_f32 v88, v88
    v_exp_f32 v89, v89
    v_smfmac_f32_32x32x32_bf16 v[144:159], v[40:43], v[80:87], v2
    v_exp_f32 v90, v90
    v_exp_f32 v91, v91
    v_exp_f32 v92, v92
    v_exp_f32 v93, v93
    v_exp_f32 v94, v94
    v_exp_f32 v95, v95
    v_exp_f32 v64, v64
    v_exp_f32 v65, v65
    v_smfmac_f32_32x32x32_bf16 v[144:159], v[44:47], v[88:95], v2
    v_exp_f32 v66, v66
    buffer_load_dwordx4 v[200:203], v3, s[12:15], s86 offen sc1
    s_add_u32 s86, s86, s89
    s_add_u32 s55, s26, 14336
    s_mov_b64 exec, s[62:63]
    buffer_load_dwordx4 v[112:115], v3, s[12:15], s55 offen sc1
    s_mov_b64 exec, -1
    v_exp_f32 v67, v67
    v_exp_f32 v68, v68
    v_mfma_f32_32x32x16_bf16 v[80:95], v[36:39], v[108:111], 4.0
    v_exp_f32 v69, v69
    v_exp_f32 v70, v70
    v_exp_f32 v71, v71
    v_exp_f32 v72, v72
    v_exp_f32 v73, v73
    v_smfmac_f32_32x32x32_bf16 v[160:175], v[40:43], v[64:71], v2
    v_exp_f32 v74, v74
    v_exp_f32 v75, v75
    v_exp_f32 v76, v76
    v_exp_f32 v77, v77
    v_exp_f32 v78, v78
    v_exp_f32 v79, v79
    v_exp_f32 v80, v80
    v_exp_f32 v81, v81
    v_smfmac_f32_32x32x32_bf16 v[160:175], v[44:47], v[72:79], v2
    v_exp_f32 v82, v82
    buffer_load_dwordx4 v[204:207], v3, s[12:15], s86 offen sc1
    s_add_u32 s86, s86, s89
    v_exp_f32 v83, v83
    v_exp_f32 v84, v84
    s_waitcnt vmcnt(8)
    v_mfma_f32_32x32x16_bf16 v[64:79], v[48:51], v[96:99], 4.0
    v_exp_f32 v85, v85
    v_exp_f32 v86, v86
    v_exp_f32 v87, v87
    v_exp_f32 v88, v88
    v_exp_f32 v89, v89
    v_smfmac_f32_32x32x32_bf16 v[176:191], v[40:43], v[80:87], v2
    v_exp_f32 v90, v90
    v_exp_f32 v91, v91
    v_exp_f32 v92, v92
    v_exp_f32 v93, v93
    v_exp_f32 v94, v94
    v_exp_f32 v95, v95
    v_exp_f32 v64, v64
    v_exp_f32 v65, v65
    v_smfmac_f32_32x32x32_bf16 v[176:191], v[44:47], v[88:95], v2
    v_exp_f32 v66, v66
    s_add_u32 s58, s84, 13
    s_and_b32 s58, s58, 15
    s_lshl_b32 s58, s58, 13
    s_add_u32 s58, s58, s68
    buffer_load_dwordx4 v[36:39], v3, s[12:15], s58 offen sc1
    s_mov_b64 exec, s[40:41]
    buffer_load_dwordx4 v[40:43], v4, s[12:15], s58 offen offset:1024 sc1
    buffer_load_dwordx4 v[44:47], v4, s[12:15], s58 offen offset:1536 sc1
    s_mov_b64 exec, -1
    buffer_load_dwordx4 v[208:211], v3, s[12:15], s86 offen sc1
    s_add_u32 s86, s86, s89
    v_exp_f32 v67, v67
    v_exp_f32 v68, v68
    v_mfma_f32_32x32x16_bf16 v[80:95], v[48:51], v[100:103], 4.0
    v_exp_f32 v69, v69
    v_exp_f32 v70, v70
    v_exp_f32 v71, v71
    v_exp_f32 v72, v72
    v_exp_f32 v73, v73
    v_smfmac_f32_32x32x32_bf16 v[128:143], v[52:55], v[64:71], v2
    v_exp_f32 v74, v74
    v_exp_f32 v75, v75
    v_exp_f32 v76, v76
    v_exp_f32 v77, v77
    v_exp_f32 v78, v78
    v_exp_f32 v79, v79
    v_exp_f32 v80, v80
    v_exp_f32 v81, v81
    v_smfmac_f32_32x32x32_bf16 v[128:143], v[56:59], v[72:79], v2
    v_exp_f32 v82, v82
    buffer_load_dwordx4 v[212:215], v3, s[12:15], s86 offen sc1
    s_add_u32 s86, s86, s89
    v_exp_f32 v83, v83
    v_exp_f32 v84, v84
    v_mfma_f32_32x32x16_bf16 v[64:79], v[48:51], v[104:107], 4.0
    v_exp_f32 v85, v85
    v_exp_f32 v86, v86
    v_exp_f32 v87, v87
    v_exp_f32 v88, v88
    v_exp_f32 v89, v89
    v_smfmac_f32_32x32x32_bf16 v[144:159], v[52:55], v[80:87], v2
    v_exp_f32 v90, v90
    v_exp_f32 v91, v91
    v_exp_f32 v92, v92
    v_exp_f32 v93, v93
    v_exp_f32 v94, v94
    v_exp_f32 v95, v95
    v_exp_f32 v64, v64
    v_exp_f32 v65, v65
    v_smfmac_f32_32x32x32_bf16 v[144:159], v[56:59], v[88:95], v2
    v_exp_f32 v66, v66
    buffer_load_dwordx4 v[216:219], v3, s[12:15], s86 offen sc1
    s_add_u32 s86, s86, s89
    s_add_u32 s55, s26, 20480
    s_mov_b64 exec, s[62:63]
    buffer_load_dwordx4 v[116:119], v3, s[12:15], s55 offen sc1
    s_mov_b64 exec, -1
    v_exp_f32 v67, v67
    v_exp_f32 v68, v68
    v_mfma_f32_32x32x16_bf16 v[80:95], v[48:51], v[108:111], 4.0
    v_exp_f32 v69, v69
    v_exp_f32 v70, v70
    v_exp_f32 v71, v71
    v_exp_f32 v72, v72
    v_exp_f32 v73, v73
    v_smfmac_f32_32x32x32_bf16 v[160:175], v[52:55], v[64:71], v2
    v_exp_f32 v74, v74
    v_exp_f32 v75, v75
    v_exp_f32 v76, v76
    v_exp_f32 v77, v77
    v_exp_f32 v78, v78
    v_exp_f32 v79, v79
    v_exp_f32 v80, v80
    v_exp_f32 v81, v81
    v_smfmac_f32_32x32x32_bf16 v[160:175], v[56:59], v[72:79], v2
    v_exp_f32 v82, v82
    buffer_load_dwordx4 v[220:223], v3, s[12:15], s86 offen sc1
    s_add_u32 s86, s86, s89
    v_exp_f32 v83, v83
    v_exp_f32 v84, v84
    s_waitcnt vmcnt(13)
    v_mfma_f32_32x32x16_bf16 v[64:79], v[24:27], v[96:99], 4.0
    v_exp_f32 v85, v85
    v_exp_f32 v86, v86
    v_exp_f32 v87, v87
    v_exp_f32 v88, v88
    v_exp_f32 v89, v89
    v_smfmac_f32_32x32x32_bf16 v[176:191], v[52:55], v[80:87], v2
    v_exp_f32 v90, v90
    v_exp_f32 v91, v91
    v_exp_f32 v92, v92
    v_exp_f32 v93, v93
    v_exp_f32 v94, v94
    v_exp_f32 v95, v95
    v_exp_f32 v64, v64
    v_exp_f32 v65, v65
    v_smfmac_f32_32x32x32_bf16 v[176:191], v[56:59], v[88:95], v2
    v_exp_f32 v66, v66
    s_waitcnt lgkmcnt(0)
    s_xor_b64 s[92:93], s[92:93], s[46:47]
    s_xor_b64 s[94:95], s[94:95], s[46:47]
    s_xor_b64 s[96:97], s[96:97], s[46:47]
    s_xor_b64 s[98:99], s[98:99], s[46:47]
    s_or_b64 s[92:93], s[92:93], s[94:95]
    s_or_b64 s[96:97], s[96:97], s[98:99]
    s_or_b64 s[92:93], s[92:93], s[96:97]
    s_cbranch_scc1 Lsf_26
Lsfr_27:
    s_add_u32 s58, s84, 14
    s_and_b32 s58, s58, 15
    s_lshl_b32 s58, s58, 13
    s_add_u32 s58, s58, s68
    buffer_load_dwordx4 v[48:51], v3, s[12:15], s58 offen sc1
    s_mov_b64 exec, s[40:41]
    buffer_load_dwordx4 v[52:55], v4, s[12:15], s58 offen offset:1024 sc1
    buffer_load_dwordx4 v[56:59], v4, s[12:15], s58 offen offset:1536 sc1
    s_mov_b64 exec, -1
    buffer_load_dwordx4 v[224:227], v3, s[12:15], s86 offen sc1
    s_add_u32 s86, s86, s89
    v_exp_f32 v67, v67
    v_exp_f32 v68, v68
    v_mfma_f32_32x32x16_bf16 v[80:95], v[24:27], v[100:103], 4.0
    v_exp_f32 v69, v69
    v_exp_f32 v70, v70
    v_exp_f32 v71, v71
    v_exp_f32 v72, v72
    v_exp_f32 v73, v73
    v_smfmac_f32_32x32x32_bf16 v[128:143], v[28:31], v[64:71], v2
    v_exp_f32 v74, v74
    v_exp_f32 v75, v75
    v_exp_f32 v76, v76
    v_exp_f32 v77, v77
    v_exp_f32 v78, v78
    v_exp_f32 v79, v79
    v_exp_f32 v80, v80
    v_exp_f32 v81, v81
    v_smfmac_f32_32x32x32_bf16 v[128:143], v[32:35], v[72:79], v2
    v_exp_f32 v82, v82
    buffer_load_dwordx4 v[228:231], v3, s[12:15], s86 offen sc1
    s_add_u32 s86, s86, s89
    v_exp_f32 v83, v83
    v_exp_f32 v84, v84
    v_mfma_f32_32x32x16_bf16 v[64:79], v[24:27], v[104:107], 4.0
    v_exp_f32 v85, v85
    v_exp_f32 v86, v86
    v_exp_f32 v87, v87
    v_exp_f32 v88, v88
    v_exp_f32 v89, v89
    v_smfmac_f32_32x32x32_bf16 v[144:159], v[28:31], v[80:87], v2
    v_exp_f32 v90, v90
    v_exp_f32 v91, v91
    v_exp_f32 v92, v92
    v_exp_f32 v93, v93
    v_exp_f32 v94, v94
    v_exp_f32 v95, v95
    v_exp_f32 v64, v64
    v_exp_f32 v65, v65
    v_smfmac_f32_32x32x32_bf16 v[144:159], v[32:35], v[88:95], v2
    v_exp_f32 v66, v66
    buffer_load_dwordx4 v[232:235], v3, s[12:15], s86 offen sc1
    s_add_u32 s86, s86, s89
    s_add_u32 s55, s26, 26624
    s_mov_b64 exec, s[62:63]
    buffer_load_dwordx4 v[120:123], v3, s[12:15], s55 offen sc1
    s_mov_b64 exec, -1
    v_exp_f32 v67, v67
    v_exp_f32 v68, v68
    v_mfma_f32_32x32x16_bf16 v[80:95], v[24:27], v[108:111], 4.0
    v_exp_f32 v69, v69
    v_exp_f32 v70, v70
    v_exp_f32 v71, v71
    v_exp_f32 v72, v72
    v_exp_f32 v73, v73
    v_smfmac_f32_32x32x32_bf16 v[160:175], v[28:31], v[64:71], v2
    v_exp_f32 v74, v74
    v_exp_f32 v75, v75
    v_exp_f32 v76, v76
    v_exp_f32 v77, v77
    v_exp_f32 v78, v78
    v_exp_f32 v79, v79
    v_exp_f32 v80, v80
    v_exp_f32 v81, v81
    v_smfmac_f32_32x32x32_bf16 v[160:175], v[32:35], v[72:79], v2
    v_exp_f32 v82, v82
    buffer_load_dwordx4 v[236:239], v3, s[12:15], s86 offen sc1
    s_add_u32 s86, s86, s89
    v_exp_f32 v83, v83
    v_exp_f32 v84, v84
    s_waitcnt vmcnt(13)
    v_mfma_f32_32x32x16_bf16 v[64:79], v[36:39], v[96:99], 4.0
    v_exp_f32 v85, v85
    v_exp_f32 v86, v86
    v_exp_f32 v87, v87
    v_exp_f32 v88, v88
    v_exp_f32 v89, v89
    v_smfmac_f32_32x32x32_bf16 v[176:191], v[28:31], v[80:87], v2
    v_exp_f32 v90, v90
    v_exp_f32 v91, v91
    v_exp_f32 v92, v92
    v_exp_f32 v93, v93
    v_exp_f32 v94, v94
    v_exp_f32 v95, v95
    v_exp_f32 v64, v64
    v_exp_f32 v65, v65
    v_smfmac_f32_32x32x32_bf16 v[176:191], v[32:35], v[88:95], v2
    v_exp_f32 v66, v66
    s_add_u32 s58, s84, 15
    s_and_b32 s58, s58, 15
    s_lshl_b32 s58, s58, 13
    s_add_u32 s58, s58, s68
    buffer_load_dwordx4 v[24:27], v3, s[12:15], s58 offen sc1
    s_mov_b64 exec, s[40:41]
    buffer_load_dwordx4 v[28:31], v4, s[12:15], s58 offen offset:1024 sc1
    buffer_load_dwordx4 v[32:35], v4, s[12:15], s58 offen offset:1536 sc1
    s_mov_b64 exec, -1
    buffer_load_dwordx4 v[240:243], v3, s[12:15], s86 offen sc1
    s_add_u32 s86, s86, s89
    v_exp_f32 v67, v67
    v_exp_f32 v68, v68
    v_mfma_f32_32x32x16_bf16 v[80:95], v[36:39], v[100:103], 4.0
    v_exp_f32 v69, v69
    v_exp_f32 v70, v70
    v_exp_f32 v71, v71
    v_exp_f32 v72, v72
    v_exp_f32 v73, v73
    v_smfmac_f32_32x32x32_bf16 v[128:143], v[40:43], v[64:71], v2
    v_exp_f32 v74, v74
    v_exp_f32 v75, v75
    v_exp_f32 v76, v76
    v_exp_f32 v77, v77
    v_exp_f32 v78, v78
    v_exp_f32 v79, v79
    v_exp_f32 v80, v80
    v_exp_f32 v81, v81
    v_smfmac_f32_32x32x32_bf16 v[128:143], v[44:47], v[72:79], v2
    v_exp_f32 v82, v82
    buffer_load_dwordx4 v[244:247], v3, s[12:15], s86 offen sc1
    s_add_u32 s86, s86, s89
    v_exp_f32 v83, v83
    v_exp_f32 v84, v84
    v_mfma_f32_32x32x16_bf16 v[64:79], v[36:39], v[104:107], 4.0
    v_exp_f32 v85, v85
    v_exp_f32 v86, v86
    v_exp_f32 v87, v87
    v_exp_f32 v88, v88
    v_exp_f32 v89, v89
    v_smfmac_f32_32x32x32_bf16 v[144:159], v[40:43], v[80:87], v2
    v_exp_f32 v90, v90
    v_exp_f32 v91, v91
    v_exp_f32 v92, v92
    v_exp_f32 v93, v93
    v_exp_f32 v94, v94
    v_exp_f32 v95, v95
    v_exp_f32 v64, v64
    v_exp_f32 v65, v65
    v_smfmac_f32_32x32x32_bf16 v[144:159], v[44:47], v[88:95], v2
    v_exp_f32 v66, v66
    buffer_load_dwordx4 v[248:251], v3, s[12:15], s86 offen sc1
    s_add_u32 s55, s26, 32768
    s_mov_b64 exec, s[62:63]
    buffer_load_dwordx4 v[124:127], v3, s[12:15], s55 offen sc1
    s_mov_b64 exec, -1
    v_exp_f32 v67, v67
    v_exp_f32 v68, v68
    v_mfma_f32_32x32x16_bf16 v[80:95], v[36:39], v[108:111], 4.0
    v_exp_f32 v69, v69
    v_exp_f32 v70, v70
    v_exp_f32 v71, v71
    v_exp_f32 v72, v72
    v_exp_f32 v73, v73
    v_smfmac_f32_32x32x32_bf16 v[160:175], v[40:43], v[64:71], v2
    v_exp_f32 v74, v74
    v_exp_f32 v75, v75
    v_exp_f32 v76, v76
    v_exp_f32 v77, v77
    v_exp_f32 v78, v78
    v_exp_f32 v79, v79
    s_setprio 1
    v_exp_f32 v80, v80
    v_exp_f32 v81, v81
    v_smfmac_f32_32x32x32_bf16 v[160:175], v[44:47], v[72:79], v2
    v_exp_f32 v82, v82
    buffer_load_dwordx4 v[252:255], v3, s[12:15], s56 offen sc1
    s_getpc_b64 s[20:21]
L_pc2:
    s_mov_b32 s22, L_code_end-L_pc2
    s_lshl3_add_u32 s58, s52, s48
    s_lshl_b32 s58, s58, 7
    buffer_load_dword v8, off, s[20:23], s58
    v_exp_f32 v83, v83
    v_exp_f32 v84, v84
    s_waitcnt vmcnt(14)
    v_mfma_f32_32x32x16_bf16 v[64:79], v[48:51], v[96:99], 4.0
    v_exp_f32 v85, v85
    v_exp_f32 v86, v86
    v_exp_f32 v87, v87
    v_exp_f32 v88, v88
    v_exp_f32 v89, v89
    v_smfmac_f32_32x32x32_bf16 v[176:191], v[40:43], v[80:87], v2
    v_exp_f32 v90, v90
    v_exp_f32 v91, v91
    v_exp_f32 v92, v92
    v_exp_f32 v93, v93
    v_exp_f32 v94, v94
    v_exp_f32 v95, v95
    v_exp_f32 v64, v64
    v_exp_f32 v65, v65
    v_smfmac_f32_32x32x32_bf16 v[176:191], v[44:47], v[88:95], v2
    v_exp_f32 v66, v66
    buffer_load_dwordx4 v[60:63], v3, s[12:15], s57 offen sc1
    v_exp_f32 v67, v67
    v_exp_f32 v68, v68
    v_mfma_f32_32x32x16_bf16 v[80:95], v[48:51], v[100:103], 4.0
    v_exp_f32 v69, v69
    v_exp_f32 v70, v70
    v_exp_f32 v71, v71
    v_exp_f32 v72, v72
    v_exp_f32 v73, v73
    v_smfmac_f32_32x32x32_bf16 v[128:143], v[52:55], v[64:71], v2
    v_exp_f32 v74, v74
    v_exp_f32 v75, v75
    v_exp_f32 v76, v76
    v_exp_f32 v77, v77
    v_exp_f32 v78, v78
    v_exp_f32 v79, v79
    v_exp_f32 v80, v80
    v_exp_f32 v81, v81
    v_smfmac_f32_32x32x32_bf16 v[128:143], v[56:59], v[72:79], v2
    v_exp_f32 v82, v82
    s_lshl3_add_u32 s59, s52, s48
    s_mul_i32 s60, s59, 2048
    s_min_u32 s60, s60, 514048
    s_mul_i32 s58, s51, 516096
    s_add_u32 s58, s58, s60
    s_add_u32 s58, s58, 6291456
    s_mov_b64 exec, 65535
    buffer_load_dword v8, v14, s[12:15], s58 offen sc1
    s_lshl_b32 s58, s51, 8
    s_add_u32 s58, s58, s59
    s_lshl_b32 s58, s58, 10
    s_mov_b64 exec, 0xff
    buffer_load_dword v8, v14, s[16:19], s58 offen sc1
    s_mov_b64 exec, -1
    v_exp_f32 v83, v83
    v_exp_f32 v84, v84
    v_mfma_f32_32x32x16_bf16 v[64:79], v[48:51], v[104:107], 4.0
    v_exp_f32 v85, v85
    v_exp_f32 v86, v86
    v_exp_f32 v87, v87
    v_exp_f32 v88, v88
    v_exp_f32 v89, v89
    v_smfmac_f32_32x32x32_bf16 v[144:159], v[52:55], v[80:87], v2
    v_exp_f32 v90, v90
    v_exp_f32 v91, v91
    v_exp_f32 v92, v92
    v_exp_f32 v93, v93
    v_exp_f32 v94, v94
    v_exp_f32 v95, v95
    v_exp_f32 v64, v64
    v_exp_f32 v65, v65
    v_smfmac_f32_32x32x32_bf16 v[144:159], v[56:59], v[88:95], v2
    v_exp_f32 v66, v66
    v_exp_f32 v67, v67
    v_exp_f32 v68, v68
    v_mfma_f32_32x32x16_bf16 v[80:95], v[48:51], v[108:111], 4.0
    v_exp_f32 v69, v69
    v_exp_f32 v70, v70
    v_exp_f32 v71, v71
    v_exp_f32 v72, v72
    v_exp_f32 v73, v73
    v_smfmac_f32_32x32x32_bf16 v[160:175], v[52:55], v[64:71], v2
    v_exp_f32 v74, v74
    v_exp_f32 v75, v75
    v_exp_f32 v76, v76
    v_exp_f32 v77, v77
    v_exp_f32 v78, v78
    v_exp_f32 v79, v79
    v_exp_f32 v80, v80
    v_exp_f32 v81, v81
    v_smfmac_f32_32x32x32_bf16 v[160:175], v[56:59], v[72:79], v2
    v_exp_f32 v82, v82
    v_exp_f32 v83, v83
    v_exp_f32 v84, v84
    s_waitcnt vmcnt(9)
    v_mfma_f32_32x32x16_bf16 v[64:79], v[24:27], v[96:99], 4.0
    v_exp_f32 v85, v85
    v_exp_f32 v86, v86
    v_exp_f32 v87, v87
    v_exp_f32 v88, v88
    v_exp_f32 v89, v89
    v_smfmac_f32_32x32x32_bf16 v[176:191], v[52:55], v[80:87], v2
    v_exp_f32 v90, v90
    v_exp_f32 v91, v91
    v_exp_f32 v92, v92
    v_exp_f32 v93, v93
    v_exp_f32 v94, v94
    v_exp_f32 v95, v95
    v_exp_f32 v64, v64
    v_exp_f32 v65, v65
    v_smfmac_f32_32x32x32_bf16 v[176:191], v[56:59], v[88:95], v2
    v_exp_f32 v66, v66
    v_exp_f32 v67, v67
    v_exp_f32 v68, v68
    v_mfma_f32_32x32x16_bf16 v[80:95], v[24:27], v[100:103], 4.0
    v_exp_f32 v69, v69
    v_exp_f32 v70, v70
    v_exp_f32 v71, v71
    v_exp_f32 v72, v72
    v_exp_f32 v73, v73
    v_smfmac_f32_32x32x32_bf16 v[128:143], v[28:31], v[64:71], v2
    v_exp_f32 v74, v74
    v_exp_f32 v75, v75
    v_exp_f32 v76, v76
    v_exp_f32 v77, v77
    v_exp_f32 v78, v78
    v_exp_f32 v79, v79
    v_exp_f32 v80, v80
    v_exp_f32 v81, v81
    v_smfmac_f32_32x32x32_bf16 v[128:143], v[32:35], v[72:79], v2
    v_exp_f32 v82, v82
    v_exp_f32 v83, v83
    v_exp_f32 v84, v84
    v_mfma_f32_32x32x16_bf16 v[64:79], v[24:27], v[104:107], 4.0
    v_exp_f32 v85, v85
    v_exp_f32 v86, v86
    v_exp_f32 v87, v87
    v_exp_f32 v88, v88
    v_exp_f32 v89, v89
    v_smfmac_f32_32x32x32_bf16 v[144:159], v[28:31], v[80:87], v2
    v_exp_f32 v90, v90
    v_exp_f32 v91, v91
    v_exp_f32 v92, v92
    v_exp_f32 v93, v93
    v_exp_f32 v94, v94
    v_exp_f32 v95, v95
    ds_write_b128 v10, v[128:131]
    ds_write_b128 v10, v[132:135] offset:1024
    v_sub_u32 v137, v10, v15
    ds_write_b32 v137, v136 offset:2048
    s_setprio 0
    v_exp_f32 v64, v64
    v_exp_f32 v65, v65
    v_smfmac_f32_32x32x32_bf16 v[144:159], v[32:35], v[88:95], v2
    v_exp_f32 v66, v66
    v_exp_f32 v67, v67
    v_exp_f32 v68, v68
    v_mfma_f32_32x32x16_bf16 v[80:95], v[24:27], v[108:111], 4.0
    v_exp_f32 v69, v69
    v_exp_f32 v70, v70
    v_exp_f32 v71, v71
    v_exp_f32 v72, v72
    v_exp_f32 v73, v73
    v_smfmac_f32_32x32x32_bf16 v[160:175], v[28:31], v[64:71], v2
    v_exp_f32 v74, v74
    v_exp_f32 v75, v75
    v_exp_f32 v76, v76
    v_exp_f32 v77, v77
    v_exp_f32 v78, v78
    v_exp_f32 v79, v79
    ds_write_b128 v11, v[144:147]
    ds_write_b128 v11, v[148:151] offset:1024
    v_sub_u32 v153, v11, v15
    ds_write_b32 v153, v152 offset:2048
    v_exp_f32 v80, v80
    v_exp_f32 v81, v81
    v_smfmac_f32_32x32x32_bf16 v[160:175], v[32:35], v[72:79], v2
    v_exp_f32 v82, v82
    v_exp_f32 v83, v83
    v_exp_f32 v84, v84
    v_exp_f32 v85, v85
    v_exp_f32 v86, v86
    v_exp_f32 v87, v87
    v_exp_f32 v88, v88
    v_exp_f32 v89, v89
    v_smfmac_f32_32x32x32_bf16 v[176:191], v[28:31], v[80:87], v2
    v_exp_f32 v90, v90
    v_exp_f32 v91, v91
    v_exp_f32 v92, v92
    v_exp_f32 v93, v93
    v_exp_f32 v94, v94
    v_exp_f32 v95, v95
    ds_write_b128 v12, v[160:163]
    ds_write_b128 v12, v[164:167] offset:1024
    v_sub_u32 v169, v12, v15
    ds_write_b32 v169, v168 offset:2048
    v_smfmac_f32_32x32x32_bf16 v[176:191], v[32:35], v[88:95], v2
    v_min3_f32 v65, v136, v152, v168
    v_add_f32 v66, v136, v152
    v_add_f32 v66, v66, v168
    s_nop 8
    v_add_f32 v66, v66, v184
    v_min_f32 v65, v65, v184
    v_cmp_nge_f32 vcc, 0x5d800000, v66
    s_nop 0
    s_mov_b64 s[58:59], vcc
    v_cmp_nle_f32 vcc, 0x21800000, v65
    s_nop 0
    s_or_b64 vcc, vcc, s[58:59]
    v_mov_b32 v67, 106496
    v_mov_b32 v68, 1
    s_mov_b64 exec, vcc
    ds_write_b32 v67, v68
    s_mov_b64 exec, -1
    s_waitcnt vmcnt(39) lgkmcnt(0)
    s_barrier
L_reduce:
    v_mov_b32 v67, 106496
    v_sub_u32 v69, v13, v15
    ds_read_b32 v68, v67
    ds_read_b32 v70, v69 offset:2048
    ds_read_b32 v71, v69 offset:4352
    ds_read_b32 v72, v69 offset:6656
    ds_read_b128 v[128:131], v13 offset:0
    ds_read_b128 v[132:135], v13 offset:1024
    ds_read_b128 v[136:139], v13 offset:2304
    ds_read_b128 v[140:143], v13 offset:3328
    ds_read_b128 v[144:147], v13 offset:4608
    ds_read_b128 v[148:151], v13 offset:5632
    s_lshl2_add_u32 s58, s49, 101376
    v_mov_b32 v73, s58
    v_mov_b32 v74, 0
    ds_write2_b32 v73, v74, v74 offset0:0 offset1:4
    s_lshl1_add_u32 s59, s54, s50
    s_lshl3_add_u32 s58, s59, s90
    s_add_u32 s58, s58, 63488
    v_mov_b32 v14, s58
    s_lshl_b32 s58, s59, 10
    s_add_u32 s58, s58, s90
    s_waitcnt lgkmcnt(7)
    v_cmp_ne_u32 vcc, 0, v68
    s_cbranch_vccnz L_slow
    v_add_f32 v70, v70, v71
    v_add_f32 v72, v72, v184
    v_add_f32 v70, v70, v72
    v_rcp_f32 v70, v70
    s_waitcnt lgkmcnt(5)
    v_pk_add_f32 v[176:177], v[176:177], v[128:129]
    v_pk_add_f32 v[178:179], v[178:179], v[130:131]
    v_pk_add_f32 v[180:181], v[180:181], v[132:133]
    v_pk_add_f32 v[182:183], v[182:183], v[134:135]
    s_waitcnt lgkmcnt(3)
    v_pk_add_f32 v[176:177], v[176:177], v[136:137]
    v_pk_add_f32 v[178:179], v[178:179], v[138:139]
    v_pk_add_f32 v[180:181], v[180:181], v[140:141]
    v_pk_add_f32 v[182:183], v[182:183], v[142:143]
    s_waitcnt lgkmcnt(1)
    v_pk_add_f32 v[176:177], v[176:177], v[144:145]
    v_pk_add_f32 v[178:179], v[178:179], v[146:147]
    v_pk_add_f32 v[180:181], v[180:181], v[148:149]
    v_pk_add_f32 v[182:183], v[182:183], v[150:151]
    v_pk_mul_f32 v[176:177], v[176:177], v[70:71] op_sel_hi:[1,0]
    v_pk_mul_f32 v[178:179], v[178:179], v[70:71] op_sel_hi:[1,0]
    v_pk_mul_f32 v[180:181], v[180:181], v[70:71] op_sel_hi:[1,0]
    v_pk_mul_f32 v[182:183], v[182:183], v[70:71] op_sel_hi:[1,0]
    v_cvt_pk_bf16_f32 v76, v176, v177
    v_cvt_pk_bf16_f32 v77, v178, v179
    v_cvt_pk_bf16_f32 v78, v180, v181
    v_cvt_pk_bf16_f32 v79, v182, v183
    s_cmp_eq_u32 s30, 0
    s_cbranch_scc1 Lst_28
    buffer_store_dwordx4 v[76:79], v3, s[12:15], s58 offen
Lsr_29:
    s_waitcnt lgkmcnt(0)
    s_barrier
    s_cmp_lg_u32 s50, 0
    s_cbranch_scc1 L_c_flag
    s_mul_i32 s58, s49, 15360
    s_add_u32 s58, s58, 102400
    v_add_u32 v5, s58, v3
    ds_write_b128 v5, v[192:195] offset:0
    ds_write_b128 v5, v[196:199] offset:1024
    ds_write_b128 v5, v[200:203] offset:2048
    ds_write_b128 v5, v[204:207] offset:3072
    ds_write_b128 v5, v[208:211] offset:4096
    s_and_b32 s59, s49, 1
    s_lshl_b32 s58, s59, 7
    s_add_u32 s58, s58, s91
    s_add_u32 s58, s58, 63488
    v_and_b32 v4, 15, v1
    v_lshl_add_u32 v4, v4, 3, s58
    s_lshl_b32 s59, s59, 14
    s_add_u32 s62, s59, s91
L_c_flag:
    s_waitcnt vmcnt(0)
    s_mov_b64 exec, 1
    s_cmp_eq_u32 s30, 0
    s_cbranch_scc1 Lst_30
    buffer_store_dwordx2 v[22:23], v14, s[12:15], 0 offen
Lsr_31:
    s_mov_b64 exec, -1
    s_cmp_lg_u32 s50, 0
    s_cbranch_scc1 L_c_f1
    buffer_load_dwordx2 v[8:9], v4, s[12:15], 0 offen sc1
    ds_write_b128 v5, v[212:215] offset:5120
    ds_write_b128 v5, v[216:219] offset:6144
    ds_write_b128 v5, v[220:223] offset:7168
    ds_write_b128 v5, v[224:227] offset:8192
    ds_write_b128 v5, v[228:231] offset:9216
    ds_write_b128 v5, v[232:235] offset:10240
    ds_write_b128 v5, v[236:239] offset:11264
    ds_write_b128 v5, v[240:243] offset:12288
    ds_write_b128 v5, v[244:247] offset:13312
    ds_write_b128 v5, v[248:251] offset:14336
    v_lshlrev_b32 v24, 16, v16
    v_and_b32 v25, 0xffff0000, v16
    v_lshlrev_b32 v26, 16, v17
    v_and_b32 v27, 0xffff0000, v17
    v_lshlrev_b32 v28, 16, v18
    v_and_b32 v29, 0xffff0000, v18
    v_lshlrev_b32 v30, 16, v19
    v_and_b32 v31, 0xffff0000, v19
    v_lshlrev_b32 v32, 16, v20
    v_and_b32 v33, 0xffff0000, v20
    v_lshlrev_b32 v34, 16, v21
    v_and_b32 v35, 0xffff0000, v21
    v_lshlrev_b32 v36, 16, v6
    v_and_b32 v37, 0xffff0000, v6
    v_lshlrev_b32 v38, 16, v7
    v_and_b32 v39, 0xffff0000, v7
    s_xor_b32 s58, s49, 2
    s_mul_i32 s58, s58, 15360
    s_add_u32 s58, s58, 102400
    v_add_u32 v10, s58, v3
    s_xor_b32 s58, s49, 3
    s_mul_i32 s58, s58, 15360
    s_add_u32 s58, s58, 102400
    v_add_u32 v11, s58, v3
    s_lshl2_add_u32 s58, s49, 101376
    v_mov_b32 v15, s58
    s_waitcnt lgkmcnt(0)
    s_barrier
    ds_read_b128 v[128:131], v10 offset:0
    ds_read_b128 v[132:135], v10 offset:1024
    ds_read_b128 v[136:139], v10 offset:2048
    ds_read_b128 v[140:143], v10 offset:3072
    ds_read_b128 v[144:147], v10 offset:4096
    ds_read_b128 v[148:151], v10 offset:5120
    ds_read_b128 v[152:155], v10 offset:6144
    ds_read_b128 v[156:159], v10 offset:7168
    ds_read_b128 v[160:163], v10 offset:8192
    ds_read_b128 v[164:167], v10 offset:9216
    ds_read_b128 v[168:171], v10 offset:10240
    ds_read_b128 v[172:175], v10 offset:11264
    ds_read_b128 v[176:179], v10 offset:12288
    ds_read_b128 v[180:183], v10 offset:13312
    ds_read_b128 v[184:187], v10 offset:14336
Lap_o_32:
    buffer_load_dwordx2 v[56:57], v4, s[12:15], 0 offen sc1
    s_add_u32 s67, s67, 1
    s_cmp_gt_u32 s67, 0x20000
    s_cselect_b64 s[60:61], 0, -1
    s_waitcnt vmcnt(1)
    v_cmp_ne_u64 vcc, s[46:47], v[8:9]
    s_cbranch_vccz Lar_o_33
    buffer_load_dwordx2 v[8:9], v4, s[12:15], 0 offen sc1
    s_waitcnt vmcnt(1)
    v_cmp_ne_u64 vcc, s[46:47], v[56:57]
    s_nop 0
    s_and_b64 vcc, vcc, s[60:61]
    s_cbranch_scc1 Lap_o_32
Lar_o_33:
    buffer_load_dwordx4 v[64:67], v3, s[12:15], s62 offen offset:0 sc1
    buffer_load_dwordx4 v[68:71], v3, s[12:15], s62 offen offset:1024 sc1
    buffer_load_dwordx4 v[72:75], v3, s[12:15], s62 offen offset:2048 sc1
    buffer_load_dwordx4 v[76:79], v3, s[12:15], s62 offen offset:3072 sc1
    s_add_u32 s62, s62, 4096
    buffer_load_dwordx4 v[80:83], v3, s[12:15], s62 offen offset:0 sc1
    buffer_load_dwordx4 v[84:87], v3, s[12:15], s62 offen offset:1024 sc1
    buffer_load_dwordx4 v[88:91], v3, s[12:15], s62 offen offset:2048 sc1
    buffer_load_dwordx4 v[92:95], v3, s[12:15], s62 offen offset:3072 sc1
    s_add_u32 s62, s62, 4096
    buffer_load_dwordx4 v[96:99], v3, s[12:15], s62 offen offset:0 sc1
    s_lshl3_add_u32 s58, s45, s91
    s_add_u32 s58, s58, 63744
    v_mov_b32 v14, s58
    s_lshl_b32 s63, s44, 15
    s_lshl_b32 s58, s45, 11
    s_add_u32 s63, s63, s58
    s_lshr_b32 s58, s45, 1
    s_lshl_b32 s58, s58, 9
    s_and_b32 s59, s45, 1
    s_lshl3_add_u32 s58, s59, s58
    s_add_u32 s58, s58, s91
    s_add_u32 s64, s58, 59392
    s_and_b32 s58, s49, 2
    s_add_u32 s58, s58, s59
    s_lshl_b32 s58, s58, 10
    s_add_u32 s58, s58, 106496
    v_add_u32 v7, s58, v3
    v_mov_b32 v12, 0
    v_mov_b32 v13, 0
    s_waitcnt lgkmcnt(0)
    s_waitcnt vmcnt(8)
    v_mfma_f32_32x32x16_bf16 v[40:55], v[128:131], v[64:67], 0
    buffer_load_dwordx4 v[100:103], v3, s[12:15], s62 offen offset:1024 sc1
    v_mfma_f32_32x32x16_bf16 v[24:39], v[192:195], v[64:67], v[24:39]
    s_waitcnt vmcnt(8)
    v_mfma_f32_32x32x16_bf16 v[40:55], v[132:135], v[68:71], v[40:55]
    buffer_load_dwordx4 v[104:107], v3, s[12:15], s62 offen offset:2048 sc1
    v_mfma_f32_32x32x16_bf16 v[24:39], v[196:199], v[68:71], v[24:39]
    s_waitcnt vmcnt(8)
    v_mfma_f32_32x32x16_bf16 v[40:55], v[136:139], v[72:75], v[40:55]
    buffer_load_dwordx4 v[108:111], v3, s[12:15], s62 offen offset:3072 sc1
    v_mfma_f32_32x32x16_bf16 v[24:39], v[200:203], v[72:75], v[24:39]
    s_waitcnt vmcnt(8)
    v_mfma_f32_32x32x16_bf16 v[40:55], v[140:143], v[76:79], v[40:55]
    s_add_u32 s62, s62, 4096
    buffer_load_dwordx4 v[112:115], v3, s[12:15], s62 offen offset:0 sc1
    v_mfma_f32_32x32x16_bf16 v[24:39], v[204:207], v[76:79], v[24:39]
    s_waitcnt vmcnt(8)
    v_mfma_f32_32x32x16_bf16 v[40:55], v[144:147], v[80:83], v[40:55]
    buffer_load_dwordx4 v[116:119], v3, s[12:15], s62 offen offset:1024 sc1
    v_mfma_f32_32x32x16_bf16 v[24:39], v[208:211], v[80:83], v[24:39]
    s_waitcnt vmcnt(8)
    v_mfma_f32_32x32x16_bf16 v[40:55], v[148:151], v[84:87], v[40:55]
    buffer_load_dwordx4 v[120:123], v3, s[12:15], s62 offen offset:2048 sc1
    v_mfma_f32_32x32x16_bf16 v[24:39], v[212:215], v[84:87], v[24:39]
    s_waitcnt vmcnt(8)
    v_mfma_f32_32x32x16_bf16 v[40:55], v[152:155], v[88:91], v[40:55]
    buffer_load_dwordx4 v[124:127], v3, s[12:15], s62 offen offset:3072 sc1
    v_mov_b32 v5, 1
    ds_write_b32 v15, v5
    v_mfma_f32_32x32x16_bf16 v[24:39], v[216:219], v[88:91], v[24:39]
    s_waitcnt vmcnt(8)
    v_mfma_f32_32x32x16_bf16 v[40:55], v[156:159], v[92:95], v[40:55]
    v_mfma_f32_32x32x16_bf16 v[24:39], v[220:223], v[92:95], v[24:39]
    s_waitcnt vmcnt(7)
    v_mfma_f32_32x32x16_bf16 v[40:55], v[160:163], v[96:99], v[40:55]
    v_mfma_f32_32x32x16_bf16 v[24:39], v[224:227], v[96:99], v[24:39]
    s_waitcnt vmcnt(6)
    v_mfma_f32_32x32x16_bf16 v[40:55], v[164:167], v[100:103], v[40:55]
    v_mfma_f32_32x32x16_bf16 v[24:39], v[228:231], v[100:103], v[24:39]
    s_waitcnt vmcnt(5)
    v_mfma_f32_32x32x16_bf16 v[40:55], v[168:171], v[104:107], v[40:55]
    v_mfma_f32_32x32x16_bf16 v[24:39], v[232:235], v[104:107], v[24:39]
    s_waitcnt vmcnt(4)
    v_mfma_f32_32x32x16_bf16 v[40:55], v[172:175], v[108:111], v[40:55]
    v_mfma_f32_32x32x16_bf16 v[24:39], v[236:239], v[108:111], v[24:39]
    s_waitcnt vmcnt(3)
    v_mfma_f32_32x32x16_bf16 v[40:55], v[176:179], v[112:115], v[40:55]
    v_mfma_f32_32x32x16_bf16 v[24:39], v[240:243], v[112:115], v[24:39]
    s_waitcnt vmcnt(2)
    v_mfma_f32_32x32x16_bf16 v[40:55], v[180:183], v[116:119], v[40:55]
    v_mfma_f32_32x32x16_bf16 v[24:39], v[244:247], v[116:119], v[24:39]
    s_waitcnt vmcnt(1)
    v_mfma_f32_32x32x16_bf16 v[40:55], v[184:187], v[120:123], v[40:55]
    v_mfma_f32_32x32x16_bf16 v[24:39], v[248:251], v[120:123], v[24:39]
    s_waitcnt vmcnt(0)
    v_mfma_f32_32x32x16_bf16 v[40:55], v[60:63], v[124:127], v[40:55]
    v_mfma_f32_32x32x16_bf16 v[24:39], v[252:255], v[124:127], v[24:39]
    s_nop 10
    ds_write_b128 v10, v[40:43] offset:0
    ds_write_b128 v10, v[44:47] offset:1024
    ds_write_b128 v10, v[48:51] offset:2048
    ds_write_b128 v10, v[52:55] offset:3072
    s_waitcnt lgkmcnt(0)
    s_barrier
    ds_read_b128 v[64:67], v11 offset:0
    ds_read_b128 v[68:71], v11 offset:1024
    ds_read_b128 v[72:75], v11 offset:2048
    ds_read_b128 v[76:79], v11 offset:3072
    s_waitcnt lgkmcnt(3)
    v_pk_add_f32 v[24:25], v[24:25], v[64:65]
    v_pk_add_f32 v[26:27], v[26:27], v[66:67]
    v_cvt_pk_bf16_f32 v80, v24, v25
    v_cvt_pk_bf16_f32 v81, v26, v27
    v_dot2c_f32_bf16 v12, s3, v80
    v_dot2c_f32_bf16 v13, v80, v80
    v_dot2c_f32_bf16 v12, s3, v81
    v_dot2c_f32_bf16 v13, v81, v81
    s_waitcnt lgkmcnt(2)
    v_pk_add_f32 v[28:29], v[28:29], v[68:69]
    v_pk_add_f32 v[30:31], v[30:31], v[70:71]
    v_cvt_pk_bf16_f32 v82, v28, v29
    v_cvt_pk_bf16_f32 v83, v30, v31
    v_dot2c_f32_bf16 v12, s3, v82
    v_dot2c_f32_bf16 v13, v82, v82
    v_dot2c_f32_bf16 v12, s3, v83
    v_dot2c_f32_bf16 v13, v83, v83
    s_waitcnt lgkmcnt(1)
    v_pk_add_f32 v[32:33], v[32:33], v[72:73]
    v_pk_add_f32 v[34:35], v[34:35], v[74:75]
    v_cvt_pk_bf16_f32 v84, v32, v33
    v_cvt_pk_bf16_f32 v85, v34, v35
    v_dot2c_f32_bf16 v12, s3, v84
    v_dot2c_f32_bf16 v13, v84, v84
    v_dot2c_f32_bf16 v12, s3, v85
    v_dot2c_f32_bf16 v13, v85, v85
    s_waitcnt lgkmcnt(0)
    v_pk_add_f32 v[36:37], v[36:37], v[76:77]
    v_pk_add_f32 v[38:39], v[38:39], v[78:79]
    v_cvt_pk_bf16_f32 v86, v36, v37
    v_cvt_pk_bf16_f32 v87, v38, v39
    v_dot2c_f32_bf16 v12, s3, v86
    v_dot2c_f32_bf16 v13, v86, v86
    v_dot2c_f32_bf16 v12, s3, v87
    v_dot2c_f32_bf16 v13, v87, v87
    s_cmp_eq_u32 s30, 0
    s_cbranch_scc1 Lst_34
    buffer_store_dwordx4 v[80:83], v3, s[16:19], s63 offen
    buffer_store_dwordx4 v[84:87], v3, s[16:19], s63 offen offset:1024
Lsr_35:
    v_mov_b32 v10, v12
    v_mov_b32 v11, v13
    s_nop 0
    v_permlane32_swap_b32 v10, v12
    v_permlane32_swap_b32 v11, v13
    v_pk_add_f32 v[10:11], v[10:11], v[12:13]
    s_mov_b32 exec_hi, 0
    s_cmp_eq_u32 s30, 0
    s_cbranch_scc1 Lst_36
    buffer_store_dwordx2 v[10:11], v3, s[12:15], s64 offen
Lsr_37:
    s_mov_b32 exec_hi, -1
    ds_write_b128 v7, v[80:83]
    ds_write_b128 v7, v[84:87] offset:4096
    s_waitcnt lgkmcnt(0)
    s_barrier
    s_add_u32 s58, s90, 63744
    v_and_b32 v4, 15, v1
    v_lshl_add_u32 v4, v4, 3, s58
    s_lshl2_add_u32 s58, s53, s49
    s_lshl_b32 s63, s58, 15
    s_add_u32 s64, s90, 59392
    v_bfe_u32 v2, v1, 2, 2
    v_lshrrev_b32 v7, 5, v1
    v_lshl_add_u32 v2, v7, 2, v2
    v_lshrrev_b32 v7, 2, v1
    v_and_b32 v7, 4, v7
    v_and_or_b32 v7, v1, 3, v7
    v_lshlrev_b32 v7, 3, v7
    s_movk_i32 s58, 192
    v_mad_u32_u24 v2, v2, s58, v7
    v_add_u32 v5, 61440, v2
    v_add_u32 v6, 98304, v3
    s_cmp_eq_u32 s54, 15
    s_cselect_b32 s58, 1073741824, 0
    v_add_u32 v0, s58, v3
    s_waitcnt vmcnt(0)
    s_mov_b64 exec, 1
    s_cmp_eq_u32 s30, 0
    s_cbranch_scc1 Lst_38
    buffer_store_dwordx2 v[22:23], v14, s[12:15], 0 offen
Lsr_39:
    s_mov_b64 exec, -1
    buffer_load_dwordx2 v[8:9], v4, s[12:15], 0 offen sc1
    ds_read_b64_tr_b16 v[44:45], v2 offset:0
    ds_read_b64_tr_b16 v[46:47], v2 offset:1536
    ds_read_b64_tr_b16 v[48:49], v2 offset:64
    ds_read_b64_tr_b16 v[50:51], v2 offset:1600
    ds_read_b64_tr_b16 v[52:53], v2 offset:3072
    ds_read_b64_tr_b16 v[54:55], v2 offset:4608
    ds_read_b64_tr_b16 v[56:57], v2 offset:3136
    ds_read_b64_tr_b16 v[58:59], v2 offset:4672
    ds_read_b64_tr_b16 v[60:61], v2 offset:6144
    ds_read_b64_tr_b16 v[62:63], v2 offset:7680
    s_and_b32 s59, s49, 1
    s_lshl_b32 s59, s59, 10
    s_add_u32 s27, s91, s59
    s_lshl_b32 s86, s44, 15
    s_add_u32 s86, s86, s59
    s_lshl_b32 s65, s49, 10
    s_mov_b32 s92, 1073741824
    s_mov_b32 s93, 1073741824
    s_mul_i32 s59, s54, 3
    s_add_u32 s58, s59, 0
    s_add_u32 s60, s54, 0
    s_lshl_b32 s60, s60, 11
    s_add_u32 s60, s60, s90
    s_lshl3_add_u32 s61, s58, s90
    s_add_u32 s61, s61, 64000
    s_cmp_lt_u32 s58, 43
    s_cselect_b64 s[60:61], s[60:61], s[92:93]
    v_add_u32 v16, s60, v3
    v_mov_b32 v19, s61
    s_add_u32 s58, s59, 1
    s_add_u32 s60, s54, 15
    s_lshl_b32 s60, s60, 11
    s_add_u32 s60, s60, s90
    s_lshl3_add_u32 s61, s58, s90
    s_add_u32 s61, s61, 64000
    s_cmp_lt_u32 s58, 43
    s_cselect_b64 s[60:61], s[60:61], s[92:93]
    v_add_u32 v17, s60, v3
    v_mov_b32 v20, s61
    s_add_u32 s58, s59, 2
    s_lshl2_add_u32 s60, s53, s49
    s_lshl4_add_u32 s60, s60, s54
    s_lshl_b32 s60, s60, 11
    s_lshl3_add_u32 s61, s58, s90
    s_add_u32 s61, s61, 64000
    s_cmp_lt_u32 s58, 43
    s_cselect_b64 s[60:61], s[60:61], s[92:93]
    v_add_u32 v18, s60, v3
    v_mov_b32 v21, s61
Lap_h_40:
    buffer_load_dwordx2 v[26:27], v4, s[12:15], 0 offen sc1
    s_add_u32 s67, s67, 1
    s_cmp_gt_u32 s67, 0x20000
    s_cselect_b64 s[60:61], 0, -1
    s_waitcnt vmcnt(1)
    v_cmp_ne_u64 vcc, s[46:47], v[8:9]
    s_cbranch_vccz Lar_h_41
    buffer_load_dwordx2 v[8:9], v4, s[12:15], 0 offen sc1
    s_waitcnt vmcnt(1)
    v_cmp_ne_u64 vcc, s[46:47], v[26:27]
    s_nop 0
    s_and_b64 vcc, vcc, s[60:61]
    s_cbranch_scc1 Lap_h_40
Lar_h_41:
    buffer_load_dwordx4 v[124:127], v0, s[16:19], s63 offen offset:0 sc1
    buffer_load_dwordx4 v[128:131], v0, s[16:19], s63 offen offset:1024 sc1
    buffer_load_dwordx4 v[132:135], v0, s[16:19], s63 offen offset:2048 sc1
    buffer_load_dwordx4 v[136:139], v0, s[16:19], s63 offen offset:3072 sc1
    s_add_u32 s63, s63, 4096
    buffer_load_dwordx4 v[140:143], v0, s[16:19], s63 offen offset:0 sc1
    buffer_load_dwordx4 v[144:147], v0, s[16:19], s63 offen offset:1024 sc1
    buffer_load_dwordx4 v[148:151], v0, s[16:19], s63 offen offset:2048 sc1
    buffer_load_dwordx4 v[152:155], v0, s[16:19], s63 offen offset:3072 sc1
    s_add_u32 s63, s63, 4096
    buffer_load_dwordx4 v[156:159], v0, s[16:19], s63 offen offset:0 sc1
    v_min_u32 v4, 13, v1
    v_mul_u32_u24 v4, 24, v4
    s_add_u32 s58, s91, 64008
    v_add_u32 v4, s58, v4
    v_min_u32 v7, 13, v1
    v_mul_u32_u24 v7, 24, v7
    s_add_u32 s58, s91, 64016
    v_add_u32 v7, s58, v7
    s_waitcnt vmcnt(8) lgkmcnt(8)
    v_mfma_f32_32x32x16_bf16 v[76:91], v[44:47], v[124:127], 0
    buffer_load_dwordx4 v[28:31], v3, s[12:15], s64 offen offset:0 sc1
    buffer_load_dwordx4 v[160:163], v0, s[16:19], s63 offen offset:1024 sc1
    ds_read_b64_tr_b16 v[64:65], v2 offset:6208
    ds_read_b64_tr_b16 v[66:67], v2 offset:7744
    s_waitcnt lgkmcnt(8)
    v_mfma_f32_32x32x16_bf16 v[92:107], v[48:51], v[124:127], 0
    ds_read_b64_tr_b16 v[68:69], v2 offset:9216
    ds_read_b64_tr_b16 v[70:71], v2 offset:10752
    s_waitcnt vmcnt(9) lgkmcnt(8)
    v_mfma_f32_32x32x16_bf16 v[76:91], v[52:55], v[128:131], v[76:91]
    buffer_load_dwordx4 v[32:35], v3, s[12:15], s64 offen offset:1024 sc1
    buffer_load_dwordx4 v[164:167], v0, s[16:19], s63 offen offset:2048 sc1
    ds_read_b64_tr_b16 v[72:73], v2 offset:9280
    ds_read_b64_tr_b16 v[74:75], v2 offset:10816
    s_waitcnt lgkmcnt(8)
    v_mfma_f32_32x32x16_bf16 v[92:107], v[56:59], v[128:131], v[92:107]
    ds_read_b64_tr_b16 v[44:45], v2 offset:128
    ds_read_b64_tr_b16 v[46:47], v2 offset:1664
    s_waitcnt vmcnt(10) lgkmcnt(8)
    v_mfma_f32_32x32x16_bf16 v[76:91], v[60:63], v[132:135], v[76:91]
    buffer_load_dwordx4 v[36:39], v3, s[12:15], s64 offen offset:2048 sc1
    buffer_load_dwordx4 v[168:171], v0, s[16:19], s63 offen offset:3072 sc1
    ds_read_b64_tr_b16 v[48:49], v2 offset:12288
    ds_read_b64_tr_b16 v[50:51], v2 offset:13824
    s_waitcnt lgkmcnt(8)
    v_mfma_f32_32x32x16_bf16 v[92:107], v[64:67], v[132:135], v[92:107]
    ds_read_b64_tr_b16 v[52:53], v2 offset:12352
    ds_read_b64_tr_b16 v[54:55], v2 offset:13888
    s_waitcnt vmcnt(11) lgkmcnt(8)
    v_mfma_f32_32x32x16_bf16 v[76:91], v[68:71], v[136:139], v[76:91]
    buffer_load_dwordx4 v[40:43], v3, s[12:15], s64 offen offset:3072 sc1
    s_add_u32 s63, s63, 4096
    buffer_load_dwordx4 v[172:175], v0, s[16:19], s63 offen offset:0 sc1
    ds_read_b64_tr_b16 v[56:57], v2 offset:15360
    ds_read_b64_tr_b16 v[58:59], v2 offset:16896
    s_waitcnt lgkmcnt(8)
    v_mfma_f32_32x32x16_bf16 v[92:107], v[72:75], v[136:139], v[92:107]
    ds_read_b64_tr_b16 v[60:61], v2 offset:15424
    ds_read_b64_tr_b16 v[62:63], v2 offset:16960
    s_waitcnt lgkmcnt(8)
    v_mfma_f32_32x32x16_bf16 v[108:123], v[44:47], v[124:127], 0
    ds_read_b64_tr_b16 v[64:65], v2 offset:18432
    ds_read_b64_tr_b16 v[66:67], v2 offset:19968
    s_waitcnt vmcnt(12) lgkmcnt(8)
    v_mfma_f32_32x32x16_bf16 v[76:91], v[48:51], v[140:143], v[76:91]
    buffer_load_dwordx4 v[176:179], v0, s[16:19], s63 offen offset:1024 sc1
    ds_read_b64_tr_b16 v[68:69], v2 offset:18496
    ds_read_b64_tr_b16 v[70:71], v2 offset:20032
    s_waitcnt lgkmcnt(8)
    v_mfma_f32_32x32x16_bf16 v[92:107], v[52:55], v[140:143], v[92:107]
    ds_read_b64_tr_b16 v[72:73], v2 offset:3200
    ds_read_b64_tr_b16 v[74:75], v2 offset:4736
    s_waitcnt vmcnt(12) lgkmcnt(8)
    v_mfma_f32_32x32x16_bf16 v[76:91], v[56:59], v[144:147], v[76:91]
    buffer_load_dwordx4 v[180:183], v0, s[16:19], s63 offen offset:2048 sc1
    ds_read_b64_tr_b16 v[44:45], v2 offset:21504
    ds_read_b64_tr_b16 v[46:47], v2 offset:23040
    s_waitcnt lgkmcnt(8)
    v_mfma_f32_32x32x16_bf16 v[92:107], v[60:63], v[144:147], v[92:107]
    ds_read_b64_tr_b16 v[48:49], v2 offset:21568
    ds_read_b64_tr_b16 v[50:51], v2 offset:23104
    s_waitcnt vmcnt(12) lgkmcnt(8)
    v_mfma_f32_32x32x16_bf16 v[76:91], v[64:67], v[148:151], v[76:91]
    buffer_load_dwordx4 v[184:187], v0, s[16:19], s63 offen offset:3072 sc1
    ds_read_b64_tr_b16 v[52:53], v2 offset:24576
    ds_read_b64_tr_b16 v[54:55], v2 offset:26112
    s_waitcnt lgkmcnt(8)
    v_mfma_f32_32x32x16_bf16 v[92:107], v[68:71], v[148:151], v[92:107]
    ds_read_b64_tr_b16 v[56:57], v2 offset:24640
    ds_read_b64_tr_b16 v[58:59], v2 offset:26176
    s_waitcnt lgkmcnt(8)
    v_mfma_f32_32x32x16_bf16 v[108:123], v[72:75], v[128:131], v[108:123]
    ds_read_b64_tr_b16 v[60:61], v2 offset:27648
    ds_read_b64_tr_b16 v[62:63], v2 offset:29184
    s_waitcnt vmcnt(12) lgkmcnt(8)
    v_mfma_f32_32x32x16_bf16 v[76:91], v[44:47], v[152:155], v[76:91]
    s_add_u32 s63, s63, 4096
    buffer_load_dwordx4 v[188:191], v0, s[16:19], s63 offen offset:0 sc1
    ds_read_b64_tr_b16 v[64:65], v2 offset:27712
    ds_read_b64_tr_b16 v[66:67], v2 offset:29248
    s_waitcnt lgkmcnt(8)
    v_mfma_f32_32x32x16_bf16 v[92:107], v[48:51], v[152:155], v[92:107]
    ds_read_b64_tr_b16 v[68:69], v2 offset:6272
    ds_read_b64_tr_b16 v[70:71], v2 offset:7808
    s_waitcnt vmcnt(12) lgkmcnt(8)
    v_mfma_f32_32x32x16_bf16 v[76:91], v[52:55], v[156:159], v[76:91]
    buffer_load_dwordx4 v[192:195], v0, s[16:19], s63 offen offset:1024 sc1
    ds_read_b64_tr_b16 v[72:73], v2 offset:30720
    ds_read_b64_tr_b16 v[74:75], v2 offset:32256
    s_waitcnt lgkmcnt(8)
    v_mfma_f32_32x32x16_bf16 v[92:107], v[56:59], v[156:159], v[92:107]
    ds_read_b64_tr_b16 v[44:45], v2 offset:30784
    ds_read_b64_tr_b16 v[46:47], v2 offset:32320
    s_waitcnt vmcnt(11) lgkmcnt(8)
    v_mfma_f32_32x32x16_bf16 v[76:91], v[60:63], v[160:163], v[76:91]
    buffer_load_dwordx4 v[196:199], v0, s[16:19], s63 offen offset:2048 sc1
    ds_read_b64_tr_b16 v[48:49], v2 offset:33792
    ds_read_b64_tr_b16 v[50:51], v2 offset:35328
    s_waitcnt lgkmcnt(8)
    v_mfma_f32_32x32x16_bf16 v[92:107], v[64:67], v[160:163], v[92:107]
    ds_read_b64_tr_b16 v[52:53], v2 offset:33856
    ds_read_b64_tr_b16 v[54:55], v2 offset:35392
    s_waitcnt lgkmcnt(8)
    v_mfma_f32_32x32x16_bf16 v[108:123], v[68:71], v[132:135], v[108:123]
    ds_read_b64_tr_b16 v[56:57], v2 offset:36864
    ds_read_b64_tr_b16 v[58:59], v2 offset:38400
    s_waitcnt vmcnt(10) lgkmcnt(8)
    v_mfma_f32_32x32x16_bf16 v[76:91], v[72:75], v[164:167], v[76:91]
    buffer_load_dwordx4 v[200:203], v0, s[16:19], s63 offen offset:3072 sc1
    ds_read_b64_tr_b16 v[60:61], v2 offset:36928
    ds_read_b64_tr_b16 v[62:63], v2 offset:38464
    s_waitcnt lgkmcnt(8)
    v_mfma_f32_32x32x16_bf16 v[92:107], v[44:47], v[164:167], v[92:107]
    ds_read_b64_tr_b16 v[64:65], v2 offset:9344
    ds_read_b64_tr_b16 v[66:67], v2 offset:10880
    s_waitcnt vmcnt(9) lgkmcnt(8)
    v_mfma_f32_32x32x16_bf16 v[76:91], v[48:51], v[168:171], v[76:91]
    s_add_u32 s63, s63, 4096
    buffer_load_dwordx4 v[204:207], v0, s[16:19], s63 offen offset:0 sc1
    ds_read_b64_tr_b16 v[68:69], v2 offset:39936
    ds_read_b64_tr_b16 v[70:71], v2 offset:41472
    s_waitcnt lgkmcnt(8)
    v_mfma_f32_32x32x16_bf16 v[92:107], v[52:55], v[168:171], v[92:107]
    ds_read_b64_tr_b16 v[72:73], v2 offset:40000
    ds_read_b64_tr_b16 v[74:75], v2 offset:41536
    s_waitcnt vmcnt(8) lgkmcnt(8)
    v_mfma_f32_32x32x16_bf16 v[76:91], v[56:59], v[172:175], v[76:91]
    buffer_load_dwordx4 v[208:211], v0, s[16:19], s63 offen offset:1024 sc1
    ds_read_b64_tr_b16 v[44:45], v2 offset:43008
    ds_read_b64_tr_b16 v[46:47], v2 offset:44544
    s_waitcnt lgkmcnt(8)
    v_mfma_f32_32x32x16_bf16 v[92:107], v[60:63], v[172:175], v[92:107]
    v_add_f32 v28, v28, v30
    v_add_f32 v29, v29, v31
    v_add_f32 v32, v32, v34
    ds_read_b64_tr_b16 v[48:49], v2 offset:43072
    ds_read_b64_tr_b16 v[50:51], v2 offset:44608
    s_waitcnt lgkmcnt(8)
    v_mfma_f32_32x32x16_bf16 v[108:123], v[64:67], v[136:139], v[108:123]
    v_add_f32 v33, v33, v35
    v_add_f32 v36, v36, v38
    v_add_f32 v37, v37, v39
    ds_read_b64_tr_b16 v[52:53], v2 offset:46080
    ds_read_b64_tr_b16 v[54:55], v2 offset:47616
    s_waitcnt vmcnt(8) lgkmcnt(8)
    v_mfma_f32_32x32x16_bf16 v[76:91], v[68:71], v[176:179], v[76:91]
    buffer_load_dwordx4 v[212:215], v0, s[16:19], s63 offen offset:2048 sc1
    ds_read_b64_tr_b16 v[56:57], v2 offset:46144
    ds_read_b64_tr_b16 v[58:59], v2 offset:47680
    s_waitcnt lgkmcnt(8)
    v_mfma_f32_32x32x16_bf16 v[92:107], v[72:75], v[176:179], v[92:107]
    v_add_f32 v40, v40, v42
    v_add_f32 v41, v41, v43
    v_add_f32 v28, v28, v32
    ds_read_b64_tr_b16 v[60:61], v2 offset:12416
    ds_read_b64_tr_b16 v[62:63], v2 offset:13952
    s_waitcnt vmcnt(8) lgkmcnt(8)
    v_mfma_f32_32x32x16_bf16 v[76:91], v[44:47], v[180:183], v[76:91]
    buffer_load_dwordx4 v[216:219], v0, s[16:19], s63 offen offset:3072 sc1
    ds_read_b64_tr_b16 v[64:65], v2 offset:49152
    ds_read_b64_tr_b16 v[66:67], v2 offset:50688
    s_waitcnt lgkmcnt(8)
    v_mfma_f32_32x32x16_bf16 v[92:107], v[48:51], v[180:183], v[92:107]
    v_add_f32 v29, v29, v33
    v_add_f32 v36, v36, v40
    v_add_f32 v37, v37, v41
    ds_read_b64_tr_b16 v[68:69], v2 offset:49216
    ds_read_b64_tr_b16 v[70:71], v2 offset:50752
    s_waitcnt vmcnt(8) lgkmcnt(8)
    v_mfma_f32_32x32x16_bf16 v[76:91], v[52:55], v[184:187], v[76:91]
    s_add_u32 s63, s63, 4096
    buffer_load_dwordx4 v[220:223], v0, s[16:19], s63 offen offset:0 sc1
    ds_read_b64_tr_b16 v[72:73], v2 offset:52224
    ds_read_b64_tr_b16 v[74:75], v2 offset:53760
    s_waitcnt lgkmcnt(8)
    v_mfma_f32_32x32x16_bf16 v[92:107], v[56:59], v[184:187], v[92:107]
    v_add_f32 v28, v28, v36
    v_add_f32 v29, v29, v37
    v_mov_b32 v10, v28
    ds_read_b64_tr_b16 v[44:45], v2 offset:52288
    ds_read_b64_tr_b16 v[46:47], v2 offset:53824
    s_waitcnt lgkmcnt(8)
    v_mfma_f32_32x32x16_bf16 v[108:123], v[60:63], v[140:143], v[108:123]
    v_mov_b32 v11, v29
    v_cmp_gt_u32 vcc, 32, v1
    v_permlane32_swap_b32 v28, v10
    ds_read_b64_tr_b16 v[48:49], v2 offset:55296
    ds_read_b64_tr_b16 v[50:51], v2 offset:56832
    s_waitcnt vmcnt(8) lgkmcnt(8)
    v_mfma_f32_32x32x16_bf16 v[76:91], v[64:67], v[188:191], v[76:91]
    buffer_load_dwordx4 v[224:227], v0, s[16:19], s63 offen offset:1024 sc1
    ds_read_b64_tr_b16 v[52:53], v2 offset:55360
    ds_read_b64_tr_b16 v[54:55], v2 offset:56896
    s_waitcnt lgkmcnt(8)
    v_mfma_f32_32x32x16_bf16 v[92:107], v[68:71], v[188:191], v[92:107]
    v_permlane32_swap_b32 v29, v11
    v_add_f32 v10, v28, v10
    v_add_f32 v11, v29, v11
    ds_read_b64_tr_b16 v[56:57], v2 offset:58368
    ds_read_b64_tr_b16 v[58:59], v2 offset:59904
    s_waitcnt vmcnt(8) lgkmcnt(8)
    v_mfma_f32_32x32x16_bf16 v[76:91], v[72:75], v[192:195], v[76:91]
    buffer_load_dwordx4 v[228:231], v0, s[16:19], s63 offen offset:2048 sc1
    ds_read_b64_tr_b16 v[60:61], v2 offset:58432
    ds_read_b64_tr_b16 v[62:63], v2 offset:59968
    s_waitcnt lgkmcnt(8)
    v_mfma_f32_32x32x16_bf16 v[92:107], v[44:47], v[192:195], v[92:107]
    v_mul_f32 v10, 0x3b000000, v10
    v_cvt_pk_bf16_f32 v28, -v10, -v10
    v_mul_f32 v11, 0x3b000000, v11
    ds_read_b64_tr_b16 v[64:65], v2 offset:15488
    ds_read_b64_tr_b16 v[66:67], v2 offset:17024
    s_waitcnt vmcnt(8) lgkmcnt(8)
    v_mfma_f32_32x32x16_bf16 v[76:91], v[48:51], v[196:199], v[76:91]
    buffer_load_dwordx4 v[232:235], v0, s[16:19], s63 offen offset:3072 sc1
    ds_read_b64_tr_b16 v[68:69], v5 offset:0
    ds_read_b64_tr_b16 v[70:71], v5 offset:1536
    s_waitcnt lgkmcnt(8)
    v_mfma_f32_32x32x16_bf16 v[92:107], v[52:55], v[196:199], v[92:107]
    v_fma_f32 v11, -v10, v10, v11
    v_max_f32 v11, 0, v11
    v_cvt_pk_bf16_f32 v11, v11, v11
    ds_read_b64_tr_b16 v[72:73], v5 offset:64
    ds_read_b64_tr_b16 v[74:75], v5 offset:1600
    s_waitcnt vmcnt(8) lgkmcnt(8)
    v_mfma_f32_32x32x16_bf16 v[76:91], v[56:59], v[200:203], v[76:91]
    s_add_u32 s63, s63, 4096
    buffer_load_dwordx4 v[236:239], v0, s[16:19], s63 offen offset:0 sc1
    ds_read_b64_tr_b16 v[44:45], v5 offset:3072
    ds_read_b64_tr_b16 v[46:47], v5 offset:4608
    s_waitcnt lgkmcnt(8)
    v_mfma_f32_32x32x16_bf16 v[92:107], v[60:63], v[200:203], v[92:107]
    v_and_b32 v11, 0xffff0000, v11
    v_add_f32 v11, 0x3727c5ac, v11
    v_cvt_pk_bf16_f32 v11, v11, v11
    ds_read_b64_tr_b16 v[48:49], v5 offset:3136
    ds_read_b64_tr_b16 v[50:51], v5 offset:4672
    s_waitcnt lgkmcnt(8)
    v_mfma_f32_32x32x16_bf16 v[108:123], v[64:67], v[144:147], v[108:123]
    v_and_b32 v11, 0xffff0000, v11
    v_sqrt_f32 v11, v11
    s_nop 0
    v_cvt_pk_bf16_f32 v24, v11, v11
    ds_read_b64_tr_b16 v[52:53], v5 offset:6144
    ds_read_b64_tr_b16 v[54:55], v5 offset:7680
    s_waitcnt vmcnt(8) lgkmcnt(8)
    v_mfma_f32_32x32x16_bf16 v[76:91], v[68:71], v[204:207], v[76:91]
    buffer_load_dwordx4 v[240:243], v0, s[16:19], s63 offen offset:1024 sc1
    ds_read_b64_tr_b16 v[56:57], v5 offset:6208
    ds_read_b64_tr_b16 v[58:59], v5 offset:7744
    s_waitcnt lgkmcnt(8)
    v_mfma_f32_32x32x16_bf16 v[92:107], v[72:75], v[204:207], v[92:107]
    v_and_b32 v24, 0xffff0000, v24
    v_rcp_f32 v25, v24
    v_lshrrev_b32 v29, 16, v24
    ds_read_b64_tr_b16 v[60:61], v2 offset:18560
    ds_read_b64_tr_b16 v[62:63], v2 offset:20096
    s_waitcnt vmcnt(8) lgkmcnt(8)
    v_mfma_f32_32x32x16_bf16 v[76:91], v[44:47], v[208:211], v[76:91]
    buffer_load_dwordx4 v[244:247], v0, s[16:19], s63 offen offset:2048 sc1
    ds_read_b64_tr_b16 v[64:65], v5 offset:9216
    ds_read_b64_tr_b16 v[66:67], v5 offset:10752
    s_waitcnt lgkmcnt(8)
    v_mfma_f32_32x32x16_bf16 v[92:107], v[48:51], v[208:211], v[92:107]
    v_mul_f32 v12, 0xc0135761, v25
    v_mul_f32 v11, v25, v25
    v_mul_f32 v11, 0x3d372713, v11
    ds_read_b64_tr_b16 v[68:69], v5 offset:9280
    ds_read_b64_tr_b16 v[70:71], v5 offset:10816
    s_waitcnt vmcnt(8) lgkmcnt(8)
    v_mfma_f32_32x32x16_bf16 v[76:91], v[52:55], v[212:215], v[76:91]
    buffer_load_dwordx4 v[248:251], v0, s[16:19], s63 offen offset:3072 sc1
    v_mov_b32 v9, 2
    ds_write_b32 v15, v9
    ds_read_b64_tr_b16 v[72:73], v5 offset:12288
    ds_read_b64_tr_b16 v[74:75], v5 offset:13824
    s_waitcnt lgkmcnt(9)
    v_mfma_f32_32x32x16_bf16 v[92:107], v[56:59], v[212:215], v[92:107]
    v_mul_f32 v13, v12, v11
    v_cndmask_b32 v252, v29, v28, vcc
    v_cndmask_b32 v253, v29, v28, vcc
    ds_read_b64_tr_b16 v[44:45], v5 offset:12352
    ds_read_b64_tr_b16 v[46:47], v5 offset:13888
    s_waitcnt lgkmcnt(9)
    v_mfma_f32_32x32x16_bf16 v[108:123], v[60:63], v[148:151], v[108:123]
    v_cndmask_b32 v254, v29, v28, vcc
    v_cndmask_b32 v255, v29, v28, vcc
    ds_read_b64_tr_b16 v[48:49], v5 offset:15360
    ds_read_b64_tr_b16 v[50:51], v5 offset:16896
    s_waitcnt vmcnt(8) lgkmcnt(9)
    v_mfma_f32_32x32x16_bf16 v[76:91], v[64:67], v[216:219], v[76:91]
    ds_read_b64_tr_b16 v[52:53], v5 offset:15424
    ds_read_b64_tr_b16 v[54:55], v5 offset:16960
    s_waitcnt lgkmcnt(9)
    v_mfma_f32_32x32x16_bf16 v[92:107], v[68:71], v[216:219], v[92:107]
    ds_read_b64_tr_b16 v[56:57], v2 offset:21632
    ds_read_b64_tr_b16 v[58:59], v2 offset:23168
    s_waitcnt vmcnt(7) lgkmcnt(8)
    v_mfma_f32_32x32x16_bf16 v[76:91], v[72:75], v[220:223], v[76:91]
    v_mov_b32 v8, 101392
    ds_read_b128 v[28:31], v8
    ds_read_b64_tr_b16 v[60:61], v5 offset:18432
    ds_read_b64_tr_b16 v[62:63], v5 offset:19968
    s_waitcnt lgkmcnt(9)
    v_mfma_f32_32x32x16_bf16 v[92:107], v[44:47], v[220:223], v[92:107]
    ds_read_b64_tr_b16 v[64:65], v5 offset:18496
    ds_read_b64_tr_b16 v[66:67], v5 offset:20032
    s_waitcnt vmcnt(6) lgkmcnt(9)
    v_mfma_f32_32x32x16_bf16 v[76:91], v[48:51], v[224:227], v[76:91]
    ds_read_b64_tr_b16 v[68:69], v5 offset:21504
    ds_read_b64_tr_b16 v[70:71], v5 offset:23040
    s_waitcnt lgkmcnt(9)
    v_mfma_f32_32x32x16_bf16 v[92:107], v[52:55], v[224:227], v[92:107]
    ds_read_b64_tr_b16 v[72:73], v5 offset:21568
    ds_read_b64_tr_b16 v[74:75], v5 offset:23104
    s_waitcnt lgkmcnt(9)
    v_mfma_f32_32x32x16_bf16 v[108:123], v[56:59], v[152:155], v[108:123]
    ds_read_b64_tr_b16 v[44:45], v5 offset:24576
    ds_read_b64_tr_b16 v[46:47], v5 offset:26112
    s_waitcnt vmcnt(5) lgkmcnt(8)
    v_mfma_f32_32x32x16_bf16 v[76:91], v[60:63], v[228:231], v[76:91]
    s_waitcnt lgkmcnt(10)
    v_and_b32 v28, v28, v29
    v_and_b32 v30, v30, v31
    v_and_b32 v28, v28, v30
    v_cmp_ne_u32 vcc, 1, v28
    s_cbranch_vccnz L_aug_stub
L_aug_ret:
    ds_read_b64_tr_b16 v[48:49], v5 offset:24640
    ds_read_b64_tr_b16 v[50:51], v5 offset:26176
    s_waitcnt lgkmcnt(8)
    v_mfma_f32_32x32x16_bf16 v[92:107], v[64:67], v[228:231], v[92:107]
    ds_read_b64_tr_b16 v[52:53], v2 offset:24704
    ds_read_b64_tr_b16 v[54:55], v2 offset:26240
    s_waitcnt vmcnt(4) lgkmcnt(8)
    v_mfma_f32_32x32x16_bf16 v[76:91], v[68:71], v[232:235], v[76:91]
    ds_read_b64_tr_b16 v[56:57], v5 offset:27648
    ds_read_b64_tr_b16 v[58:59], v5 offset:29184
    s_waitcnt lgkmcnt(8)
    v_mfma_f32_32x32x16_bf16 v[92:107], v[72:75], v[232:235], v[92:107]
    ds_read_b64_tr_b16 v[60:61], v5 offset:27712
    ds_read_b64_tr_b16 v[62:63], v5 offset:29248
    s_waitcnt vmcnt(3) lgkmcnt(8)
    v_mfma_f32_32x32x16_bf16 v[76:91], v[44:47], v[236:239], v[76:91]
    ds_read_b128 v[64:67], v6 offset:0
    s_waitcnt lgkmcnt(7)
    v_mfma_f32_32x32x16_bf16 v[92:107], v[48:51], v[236:239], v[92:107]
    ds_read_b128 v[68:71], v6 offset:1024
    s_waitcnt lgkmcnt(6)
    v_mfma_f32_32x32x16_bf16 v[108:123], v[52:55], v[156:159], v[108:123]
    ds_read_b64_tr_b16 v[72:73], v5 offset:30720
    ds_read_b64_tr_b16 v[74:75], v5 offset:32256
    s_waitcnt vmcnt(2) lgkmcnt(6)
    v_mfma_f32_32x32x16_bf16 v[76:91], v[56:59], v[240:243], v[76:91]
    ds_read_b64_tr_b16 v[44:45], v5 offset:30784
    ds_read_b64_tr_b16 v[46:47], v5 offset:32320
    s_waitcnt lgkmcnt(6)
    v_mfma_f32_32x32x16_bf16 v[92:107], v[60:63], v[240:243], v[92:107]
    ds_read_b64_tr_b16 v[48:49], v5 offset:33792
    ds_read_b64_tr_b16 v[50:51], v5 offset:35328
    s_waitcnt lgkmcnt(7)
    v_mfma_f32_32x32x16_bf16 v[76:91], v[64:67], v[252:255], v[76:91]
    ds_read_b64_tr_b16 v[52:53], v5 offset:33856
    ds_read_b64_tr_b16 v[54:55], v5 offset:35392
    s_waitcnt lgkmcnt(8)
    v_mfma_f32_32x32x16_bf16 v[92:107], v[68:71], v[252:255], v[92:107]
    ds_read_b64_tr_b16 v[56:57], v2 offset:27776
    ds_read_b64_tr_b16 v[58:59], v2 offset:29312
    s_waitcnt vmcnt(1) lgkmcnt(8)
    v_mfma_f32_32x32x16_bf16 v[76:91], v[72:75], v[244:247], v[76:91]
    ds_read_b128 v[60:63], v6 offset:2048
    s_waitcnt lgkmcnt(7)
    v_mfma_f32_32x32x16_bf16 v[92:107], v[44:47], v[244:247], v[92:107]
    ds_read_b64_tr_b16 v[64:65], v2 offset:30848
    ds_read_b64_tr_b16 v[66:67], v2 offset:32384
    s_waitcnt vmcnt(0) lgkmcnt(7)
    v_mfma_f32_32x32x16_bf16 v[76:91], v[48:51], v[248:251], v[76:91]
    ds_read_b64_tr_b16 v[68:69], v2 offset:33920
    ds_read_b64_tr_b16 v[70:71], v2 offset:35456
    s_waitcnt lgkmcnt(7)
    v_mfma_f32_32x32x16_bf16 v[92:107], v[52:55], v[248:251], v[92:107]
    ds_read_b64_tr_b16 v[72:73], v2 offset:36992
    ds_read_b64_tr_b16 v[74:75], v2 offset:38528
    s_waitcnt lgkmcnt(7)
    v_mfma_f32_32x32x16_bf16 v[108:123], v[56:59], v[160:163], v[108:123]
    ds_read_b64_tr_b16 v[44:45], v2 offset:40064
    ds_read_b64_tr_b16 v[46:47], v2 offset:41600
    s_nop 1
    v_pk_mul_f32 v[28:29], v[76:77], v[76:77]
    .p2align 3
    v_pk_mul_f32 v[30:31], v[78:79], v[78:79]
    v_pk_mul_f32 v[32:33], v[80:81], v[80:81]
    v_pk_mul_f32 v[34:35], v[82:83], v[82:83]
    v_pk_mul_f32 v[36:37], v[84:85], v[84:85]
    v_pk_mul_f32 v[38:39], v[86:87], v[86:87]
    v_pk_mul_f32 v[40:41], v[88:89], v[88:89]
    v_pk_mul_f32 v[42:43], v[90:91], v[90:91]
    v_pk_fma_f32 v[28:29], v[28:29], v[12:13], v[12:13] op_sel:[0,1,0] op_sel_hi:[1,1,0]
    v_pk_fma_f32 v[30:31], v[30:31], v[12:13], v[12:13] op_sel:[0,1,0] op_sel_hi:[1,1,0]
    v_pk_fma_f32 v[32:33], v[32:33], v[12:13], v[12:13] op_sel:[0,1,0] op_sel_hi:[1,1,0]
    v_pk_fma_f32 v[34:35], v[34:35], v[12:13], v[12:13] op_sel:[0,1,0] op_sel_hi:[1,1,0]
    v_pk_fma_f32 v[36:37], v[36:37], v[12:13], v[12:13] op_sel:[0,1,0] op_sel_hi:[1,1,0]
    v_pk_fma_f32 v[38:39], v[38:39], v[12:13], v[12:13] op_sel:[0,1,0] op_sel_hi:[1,1,0]
    v_pk_fma_f32 v[40:41], v[40:41], v[12:13], v[12:13] op_sel:[0,1,0] op_sel_hi:[1,1,0]
    v_pk_fma_f32 v[42:43], v[42:43], v[12:13], v[12:13] op_sel:[0,1,0] op_sel_hi:[1,1,0]
    v_pk_mul_f32 v[28:29], v[28:29], v[76:77]
    v_pk_mul_f32 v[30:31], v[30:31], v[78:79]
    v_pk_mul_f32 v[32:33], v[32:33], v[80:81]
    v_pk_mul_f32 v[34:35], v[34:35], v[82:83]
    v_pk_mul_f32 v[36:37], v[36:37], v[84:85]
    v_pk_mul_f32 v[38:39], v[38:39], v[86:87]
    v_pk_mul_f32 v[40:41], v[40:41], v[88:89]
    v_pk_mul_f32 v[42:43], v[42:43], v[90:91]
    v_exp_f32 v28, v28
    v_exp_f32 v29, v29
    v_exp_f32 v30, v30
    v_exp_f32 v31, v31
    v_exp_f32 v32, v32
    v_exp_f32 v33, v33
    v_exp_f32 v34, v34
    v_exp_f32 v35, v35
    v_exp_f32 v36, v36
    v_exp_f32 v37, v37
    v_exp_f32 v38, v38
    v_exp_f32 v39, v39
    v_exp_f32 v40, v40
    v_exp_f32 v41, v41
    v_exp_f32 v42, v42
    v_exp_f32 v43, v43
    v_pk_fma_f32 v[28:29], v[28:29], v[24:25], v[24:25] op_sel_hi:[1,0,0]
    v_pk_fma_f32 v[30:31], v[30:31], v[24:25], v[24:25] op_sel_hi:[1,0,0]
    v_pk_fma_f32 v[32:33], v[32:33], v[24:25], v[24:25] op_sel_hi:[1,0,0]
    v_pk_fma_f32 v[34:35], v[34:35], v[24:25], v[24:25] op_sel_hi:[1,0,0]
    v_pk_fma_f32 v[36:37], v[36:37], v[24:25], v[24:25] op_sel_hi:[1,0,0]
    v_pk_fma_f32 v[38:39], v[38:39], v[24:25], v[24:25] op_sel_hi:[1,0,0]
    v_pk_fma_f32 v[40:41], v[40:41], v[24:25], v[24:25] op_sel_hi:[1,0,0]
    v_pk_fma_f32 v[42:43], v[42:43], v[24:25], v[24:25] op_sel_hi:[1,0,0]
    v_rcp_f32 v28, v28
    v_rcp_f32 v29, v29
    v_rcp_f32 v30, v30
    v_rcp_f32 v31, v31
    v_rcp_f32 v32, v32
    v_rcp_f32 v33, v33
    v_rcp_f32 v34, v34
    v_rcp_f32 v35, v35
    v_rcp_f32 v36, v36
    v_rcp_f32 v37, v37
    v_rcp_f32 v38, v38
    v_rcp_f32 v39, v39
    v_rcp_f32 v40, v40
    v_rcp_f32 v41, v41
    v_rcp_f32 v42, v42
    v_rcp_f32 v43, v43
    v_pk_mul_f32 v[28:29], v[28:29], v[76:77]
    v_pk_mul_f32 v[30:31], v[30:31], v[78:79]
    v_pk_mul_f32 v[32:33], v[32:33], v[80:81]
    v_pk_mul_f32 v[34:35], v[34:35], v[82:83]
    v_pk_mul_f32 v[36:37], v[36:37], v[84:85]
    v_pk_mul_f32 v[38:39], v[38:39], v[86:87]
    v_pk_mul_f32 v[40:41], v[40:41], v[88:89]
    v_pk_mul_f32 v[42:43], v[42:43], v[90:91]
    v_cvt_pk_bf16_f32 v76, v28, v29
    v_cvt_pk_bf16_f32 v77, v30, v31
    v_cvt_pk_bf16_f32 v78, v32, v33
    v_cvt_pk_bf16_f32 v79, v34, v35
    v_cvt_pk_bf16_f32 v80, v36, v37
    v_cvt_pk_bf16_f32 v81, v38, v39
    v_cvt_pk_bf16_f32 v82, v40, v41
    v_cvt_pk_bf16_f32 v83, v42, v43
    s_cmp_eq_u32 s30, 0
    s_cbranch_scc1 Lst_42
    buffer_store_dwordx4 v[76:79], v16, s[12:15], 0 offen
    buffer_store_dwordx4 v[80:83], v16, s[12:15], 0 offen offset:1024
Lsr_43:
    v_pk_mul_f32 v[28:29], v[92:93], v[92:93]
    .p2align 3
    v_pk_mul_f32 v[30:31], v[94:95], v[94:95]
    v_pk_mul_f32 v[32:33], v[96:97], v[96:97]
    v_pk_mul_f32 v[34:35], v[98:99], v[98:99]
    v_pk_mul_f32 v[36:37], v[100:101], v[100:101]
    v_pk_mul_f32 v[38:39], v[102:103], v[102:103]
    v_pk_mul_f32 v[40:41], v[104:105], v[104:105]
    v_pk_mul_f32 v[42:43], v[106:107], v[106:107]
    v_pk_fma_f32 v[28:29], v[28:29], v[12:13], v[12:13] op_sel:[0,1,0] op_sel_hi:[1,1,0]
    v_pk_fma_f32 v[30:31], v[30:31], v[12:13], v[12:13] op_sel:[0,1,0] op_sel_hi:[1,1,0]
    v_pk_fma_f32 v[32:33], v[32:33], v[12:13], v[12:13] op_sel:[0,1,0] op_sel_hi:[1,1,0]
    v_pk_fma_f32 v[34:35], v[34:35], v[12:13], v[12:13] op_sel:[0,1,0] op_sel_hi:[1,1,0]
    v_pk_fma_f32 v[36:37], v[36:37], v[12:13], v[12:13] op_sel:[0,1,0] op_sel_hi:[1,1,0]
    v_pk_fma_f32 v[38:39], v[38:39], v[12:13], v[12:13] op_sel:[0,1,0] op_sel_hi:[1,1,0]
    v_pk_fma_f32 v[40:41], v[40:41], v[12:13], v[12:13] op_sel:[0,1,0] op_sel_hi:[1,1,0]
    v_pk_fma_f32 v[42:43], v[42:43], v[12:13], v[12:13] op_sel:[0,1,0] op_sel_hi:[1,1,0]
    v_pk_mul_f32 v[28:29], v[28:29], v[92:93]
    v_pk_mul_f32 v[30:31], v[30:31], v[94:95]
    v_pk_mul_f32 v[32:33], v[32:33], v[96:97]
    v_pk_mul_f32 v[34:35], v[34:35], v[98:99]
    v_pk_mul_f32 v[36:37], v[36:37], v[100:101]
    v_pk_mul_f32 v[38:39], v[38:39], v[102:103]
    v_pk_mul_f32 v[40:41], v[40:41], v[104:105]
    v_pk_mul_f32 v[42:43], v[42:43], v[106:107]
    v_exp_f32 v28, v28
    v_exp_f32 v29, v29
    v_exp_f32 v30, v30
    v_exp_f32 v31, v31
    v_exp_f32 v32, v32
    v_exp_f32 v33, v33
    v_exp_f32 v34, v34
    v_exp_f32 v35, v35
    v_exp_f32 v36, v36
    v_exp_f32 v37, v37
    v_exp_f32 v38, v38
    v_exp_f32 v39, v39
    v_exp_f32 v40, v40
    v_exp_f32 v41, v41
    v_exp_f32 v42, v42
    v_exp_f32 v43, v43
    v_pk_fma_f32 v[28:29], v[28:29], v[24:25], v[24:25] op_sel_hi:[1,0,0]
    v_pk_fma_f32 v[30:31], v[30:31], v[24:25], v[24:25] op_sel_hi:[1,0,0]
    v_pk_fma_f32 v[32:33], v[32:33], v[24:25], v[24:25] op_sel_hi:[1,0,0]
    v_pk_fma_f32 v[34:35], v[34:35], v[24:25], v[24:25] op_sel_hi:[1,0,0]
    v_pk_fma_f32 v[36:37], v[36:37], v[24:25], v[24:25] op_sel_hi:[1,0,0]
    v_pk_fma_f32 v[38:39], v[38:39], v[24:25], v[24:25] op_sel_hi:[1,0,0]
    v_pk_fma_f32 v[40:41], v[40:41], v[24:25], v[24:25] op_sel_hi:[1,0,0]
    v_pk_fma_f32 v[42:43], v[42:43], v[24:25], v[24:25] op_sel_hi:[1,0,0]
    v_rcp_f32 v28, v28
    v_rcp_f32 v29, v29
    v_rcp_f32 v30, v30
    v_rcp_f32 v31, v31
    v_rcp_f32 v32, v32
    v_rcp_f32 v33, v33
    v_rcp_f32 v34, v34
    v_rcp_f32 v35, v35
    v_rcp_f32 v36, v36
    v_rcp_f32 v37, v37
    v_rcp_f32 v38, v38
    v_rcp_f32 v39, v39
    v_rcp_f32 v40, v40
    v_rcp_f32 v41, v41
    v_rcp_f32 v42, v42
    v_rcp_f32 v43, v43
    v_pk_mul_f32 v[28:29], v[28:29], v[92:93]
    v_pk_mul_f32 v[30:31], v[30:31], v[94:95]
    v_pk_mul_f32 v[32:33], v[32:33], v[96:97]
    v_pk_mul_f32 v[34:35], v[34:35], v[98:99]
    v_pk_mul_f32 v[36:37], v[36:37], v[100:101]
    v_pk_mul_f32 v[38:39], v[38:39], v[102:103]
    v_pk_mul_f32 v[40:41], v[40:41], v[104:105]
    v_pk_mul_f32 v[42:43], v[42:43], v[106:107]
    s_waitcnt vmcnt(0)
    s_mov_b64 exec, 1
    s_cmp_eq_u32 s30, 0
    s_cbranch_scc1 Lst_44
    buffer_store_dwordx2 v[22:23], v19, s[12:15], 0 offen
Lsr_45:
    s_mov_b64 exec, -1
    v_mov_b32 v9, 3
    ds_write_b32 v15, v9
    v_cvt_pk_bf16_f32 v92, v28, v29
    v_cvt_pk_bf16_f32 v93, v30, v31
    v_cvt_pk_bf16_f32 v94, v32, v33
    v_cvt_pk_bf16_f32 v95, v34, v35
    v_cvt_pk_bf16_f32 v96, v36, v37
    v_cvt_pk_bf16_f32 v97, v38, v39
    v_cvt_pk_bf16_f32 v98, v40, v41
    v_cvt_pk_bf16_f32 v99, v42, v43
    s_cmp_eq_u32 s30, 0
    s_cbranch_scc1 Lst_46
    buffer_store_dwordx4 v[92:95], v17, s[12:15], 0 offen
    buffer_store_dwordx4 v[96:99], v17, s[12:15], 0 offen offset:1024
Lsr_47:
    s_waitcnt lgkmcnt(9)
    v_mfma_f32_32x32x16_bf16 v[108:123], v[60:63], v[252:255], v[108:123]
    ds_read_b64_tr_b16 v[48:49], v2 offset:43136
    ds_read_b64_tr_b16 v[50:51], v2 offset:44672
    s_waitcnt lgkmcnt(9)
    v_mfma_f32_32x32x16_bf16 v[108:123], v[64:67], v[164:167], v[108:123]
    ds_read_b64_tr_b16 v[52:53], v2 offset:46208
    ds_read_b64_tr_b16 v[54:55], v2 offset:47744
    s_waitcnt lgkmcnt(9)
    v_mfma_f32_32x32x16_bf16 v[108:123], v[68:71], v[168:171], v[108:123]
    ds_read_b64_tr_b16 v[56:57], v2 offset:49280
    ds_read_b64_tr_b16 v[58:59], v2 offset:50816
    s_waitcnt lgkmcnt(9)
    v_mfma_f32_32x32x16_bf16 v[108:123], v[72:75], v[172:175], v[108:123]
    ds_read_b64_tr_b16 v[60:61], v2 offset:52352
    ds_read_b64_tr_b16 v[62:63], v2 offset:53888
    s_waitcnt lgkmcnt(9)
    v_mfma_f32_32x32x16_bf16 v[108:123], v[44:47], v[176:179], v[108:123]
    ds_read_b64_tr_b16 v[64:65], v2 offset:55424
    ds_read_b64_tr_b16 v[66:67], v2 offset:56960
    s_waitcnt lgkmcnt(8)
    v_mfma_f32_32x32x16_bf16 v[108:123], v[48:51], v[180:183], v[108:123]
    ds_read_b64_tr_b16 v[68:69], v2 offset:58496
    ds_read_b64_tr_b16 v[70:71], v2 offset:60032
    s_waitcnt lgkmcnt(8)
    v_mfma_f32_32x32x16_bf16 v[108:123], v[52:55], v[184:187], v[108:123]
    ds_read_b64_tr_b16 v[72:73], v5 offset:128
    ds_read_b64_tr_b16 v[74:75], v5 offset:1664
    s_waitcnt lgkmcnt(8)
    v_mfma_f32_32x32x16_bf16 v[108:123], v[56:59], v[188:191], v[108:123]
    ds_read_b64_tr_b16 v[44:45], v5 offset:3200
    ds_read_b64_tr_b16 v[46:47], v5 offset:4736
    s_waitcnt lgkmcnt(8)
    v_mfma_f32_32x32x16_bf16 v[108:123], v[60:63], v[192:195], v[108:123]
    ds_read_b64_tr_b16 v[48:49], v5 offset:6272
    ds_read_b64_tr_b16 v[50:51], v5 offset:7808
    s_waitcnt lgkmcnt(8)
    v_mfma_f32_32x32x16_bf16 v[108:123], v[64:67], v[196:199], v[108:123]
    ds_read_b64_tr_b16 v[52:53], v5 offset:9344
    ds_read_b64_tr_b16 v[54:55], v5 offset:10880
    s_waitcnt lgkmcnt(8)
    v_mfma_f32_32x32x16_bf16 v[108:123], v[68:71], v[200:203], v[108:123]
    ds_read_b64_tr_b16 v[56:57], v5 offset:12416
    ds_read_b64_tr_b16 v[58:59], v5 offset:13952
    s_waitcnt lgkmcnt(8)
    v_mfma_f32_32x32x16_bf16 v[108:123], v[72:75], v[204:207], v[108:123]
    ds_read_b64_tr_b16 v[60:61], v5 offset:15488
    ds_read_b64_tr_b16 v[62:63], v5 offset:17024
    s_waitcnt lgkmcnt(8)
    v_mfma_f32_32x32x16_bf16 v[108:123], v[44:47], v[208:211], v[108:123]
    ds_read_b64_tr_b16 v[64:65], v5 offset:18560
    ds_read_b64_tr_b16 v[66:67], v5 offset:20096
    s_waitcnt lgkmcnt(8)
    v_mfma_f32_32x32x16_bf16 v[108:123], v[48:51], v[212:215], v[108:123]
    ds_read_b64_tr_b16 v[68:69], v5 offset:21632
    ds_read_b64_tr_b16 v[70:71], v5 offset:23168
    s_waitcnt vmcnt(0)
    s_mov_b64 exec, 1
    s_cmp_eq_u32 s30, 0
    s_cbranch_scc1 Lst_48
    buffer_store_dwordx2 v[22:23], v20, s[12:15], 0 offen
Lsr_49:
    s_mov_b64 exec, -1
    s_waitcnt lgkmcnt(8)
    v_mfma_f32_32x32x16_bf16 v[108:123], v[52:55], v[216:219], v[108:123]
    ds_read_b64_tr_b16 v[72:73], v5 offset:24704
    ds_read_b64_tr_b16 v[74:75], v5 offset:26240
    s_waitcnt lgkmcnt(8)
    v_mfma_f32_32x32x16_bf16 v[108:123], v[56:59], v[220:223], v[108:123]
    ds_read_b64_tr_b16 v[44:45], v5 offset:27776
    ds_read_b64_tr_b16 v[46:47], v5 offset:29312
    s_waitcnt lgkmcnt(8)
    v_mfma_f32_32x32x16_bf16 v[108:123], v[60:63], v[224:227], v[108:123]
    ds_read_b64_tr_b16 v[48:49], v5 offset:30848
    ds_read_b64_tr_b16 v[50:51], v5 offset:32384
    s_waitcnt lgkmcnt(8)
    v_mfma_f32_32x32x16_bf16 v[108:123], v[64:67], v[228:231], v[108:123]
    ds_read_b64_tr_b16 v[52:53], v5 offset:33920
    ds_read_b64_tr_b16 v[54:55], v5 offset:35456
    s_waitcnt lgkmcnt(8)
    v_mfma_f32_32x32x16_bf16 v[108:123], v[68:71], v[232:235], v[108:123]
    s_waitcnt lgkmcnt(6)
    v_mfma_f32_32x32x16_bf16 v[108:123], v[72:75], v[236:239], v[108:123]
    s_waitcnt lgkmcnt(4)
    v_mfma_f32_32x32x16_bf16 v[108:123], v[44:47], v[240:243], v[108:123]
    s_waitcnt lgkmcnt(2)
    v_mfma_f32_32x32x16_bf16 v[108:123], v[48:51], v[244:247], v[108:123]
    s_waitcnt lgkmcnt(0)
    v_mfma_f32_32x32x16_bf16 v[108:123], v[52:55], v[248:251], v[108:123]
    v_min_u32 v10, 14, v1
    v_mul_u32_u24 v10, 24, v10
    s_add_u32 s58, s90, 64000
    v_add_u32 v10, s58, v10
    buffer_load_dwordx2 v[8:9], v10, s[12:15], 0 offen sc1
    s_nop 6
    v_pk_mul_f32 v[28:29], v[108:109], v[108:109]
    .p2align 3
    v_pk_mul_f32 v[30:31], v[110:111], v[110:111]
    v_pk_mul_f32 v[32:33], v[112:113], v[112:113]
    v_pk_mul_f32 v[34:35], v[114:115], v[114:115]
    v_pk_mul_f32 v[36:37], v[116:117], v[116:117]
    v_pk_mul_f32 v[38:39], v[118:119], v[118:119]
    v_pk_mul_f32 v[40:41], v[120:121], v[120:121]
    v_pk_mul_f32 v[42:43], v[122:123], v[122:123]
    v_pk_fma_f32 v[28:29], v[28:29], v[12:13], v[12:13] op_sel:[0,1,0] op_sel_hi:[1,1,0]
    v_pk_fma_f32 v[30:31], v[30:31], v[12:13], v[12:13] op_sel:[0,1,0] op_sel_hi:[1,1,0]
    v_pk_fma_f32 v[32:33], v[32:33], v[12:13], v[12:13] op_sel:[0,1,0] op_sel_hi:[1,1,0]
    v_pk_fma_f32 v[34:35], v[34:35], v[12:13], v[12:13] op_sel:[0,1,0] op_sel_hi:[1,1,0]
    v_pk_fma_f32 v[36:37], v[36:37], v[12:13], v[12:13] op_sel:[0,1,0] op_sel_hi:[1,1,0]
    v_pk_fma_f32 v[38:39], v[38:39], v[12:13], v[12:13] op_sel:[0,1,0] op_sel_hi:[1,1,0]
    v_pk_fma_f32 v[40:41], v[40:41], v[12:13], v[12:13] op_sel:[0,1,0] op_sel_hi:[1,1,0]
    v_pk_fma_f32 v[42:43], v[42:43], v[12:13], v[12:13] op_sel:[0,1,0] op_sel_hi:[1,1,0]
    v_pk_mul_f32 v[28:29], v[28:29], v[108:109]
    v_pk_mul_f32 v[30:31], v[30:31], v[110:111]
    v_pk_mul_f32 v[32:33], v[32:33], v[112:113]
    v_pk_mul_f32 v[34:35], v[34:35], v[114:115]
    v_pk_mul_f32 v[36:37], v[36:37], v[116:117]
    v_pk_mul_f32 v[38:39], v[38:39], v[118:119]
    v_pk_mul_f32 v[40:41], v[40:41], v[120:121]
    v_pk_mul_f32 v[42:43], v[42:43], v[122:123]
    v_exp_f32 v28, v28
    v_exp_f32 v29, v29
    v_exp_f32 v30, v30
    v_exp_f32 v31, v31
    v_exp_f32 v32, v32
    v_exp_f32 v33, v33
    v_exp_f32 v34, v34
    v_exp_f32 v35, v35
    v_exp_f32 v36, v36
    v_exp_f32 v37, v37
    v_exp_f32 v38, v38
    v_exp_f32 v39, v39
    v_exp_f32 v40, v40
    v_exp_f32 v41, v41
    v_exp_f32 v42, v42
    v_exp_f32 v43, v43
    v_pk_fma_f32 v[28:29], v[28:29], v[24:25], v[24:25] op_sel_hi:[1,0,0]
    v_pk_fma_f32 v[30:31], v[30:31], v[24:25], v[24:25] op_sel_hi:[1,0,0]
    v_pk_fma_f32 v[32:33], v[32:33], v[24:25], v[24:25] op_sel_hi:[1,0,0]
    v_pk_fma_f32 v[34:35], v[34:35], v[24:25], v[24:25] op_sel_hi:[1,0,0]
    v_pk_fma_f32 v[36:37], v[36:37], v[24:25], v[24:25] op_sel_hi:[1,0,0]
    v_pk_fma_f32 v[38:39], v[38:39], v[24:25], v[24:25] op_sel_hi:[1,0,0]
    v_pk_fma_f32 v[40:41], v[40:41], v[24:25], v[24:25] op_sel_hi:[1,0,0]
    v_pk_fma_f32 v[42:43], v[42:43], v[24:25], v[24:25] op_sel_hi:[1,0,0]
    v_rcp_f32 v28, v28
    v_rcp_f32 v29, v29
    v_rcp_f32 v30, v30
    v_rcp_f32 v31, v31
    v_rcp_f32 v32, v32
    v_rcp_f32 v33, v33
    v_rcp_f32 v34, v34
    v_rcp_f32 v35, v35
    v_rcp_f32 v36, v36
    v_rcp_f32 v37, v37
    v_rcp_f32 v38, v38
    v_rcp_f32 v39, v39
    v_rcp_f32 v40, v40
    v_rcp_f32 v41, v41
    v_rcp_f32 v42, v42
    v_rcp_f32 v43, v43
    v_pk_mul_f32 v[28:29], v[28:29], v[108:109]
    v_pk_mul_f32 v[30:31], v[30:31], v[110:111]
    v_pk_mul_f32 v[32:33], v[32:33], v[112:113]
    v_pk_mul_f32 v[34:35], v[34:35], v[114:115]
    v_pk_mul_f32 v[36:37], v[36:37], v[116:117]
    v_pk_mul_f32 v[38:39], v[38:39], v[118:119]
    v_pk_mul_f32 v[40:41], v[40:41], v[120:121]
    v_pk_mul_f32 v[42:43], v[42:43], v[122:123]
    v_cvt_pk_bf16_f32 v108, v28, v29
    v_cvt_pk_bf16_f32 v109, v30, v31
    v_cvt_pk_bf16_f32 v110, v32, v33
    v_cvt_pk_bf16_f32 v111, v34, v35
    v_cvt_pk_bf16_f32 v112, v36, v37
    v_cvt_pk_bf16_f32 v113, v38, v39
    v_cvt_pk_bf16_f32 v114, v40, v41
    v_cvt_pk_bf16_f32 v115, v42, v43
    s_waitcnt vmcnt(0)
    v_cmp_ne_u64 vcc, s[46:47], v[8:9]
    s_cbranch_vccnz Lap_hd_50
Lar_hd_51:
    s_cmp_eq_u32 s30, 0
    s_cbranch_scc1 Lst_52
    buffer_store_dwordx4 v[108:111], v18, s[16:19], 0 offen
    buffer_store_dwordx4 v[112:115], v18, s[16:19], 0 offen offset:1024
Lsr_53:
    buffer_load_dwordx2 v[8:9], v4, s[12:15], 0 offen sc1
    s_barrier
    s_waitcnt vmcnt(1)
    s_mov_b64 exec, 1
    s_cmp_eq_u32 s30, 0
    s_cbranch_scc1 Lst_54
    buffer_store_dwordx2 v[22:23], v21, s[12:15], 0 offen
Lsr_55:
    s_mov_b64 exec, -1
    s_waitcnt vmcnt(1)
    v_cmp_ne_u64 vcc, s[46:47], v[8:9]
    s_cbranch_vccnz Lap_g1_56
Lar_g1_57:
    s_add_u32 m0, s65, 0
    s_add_u32 s58, s27, 30720
    buffer_load_dwordx4 v3, s[12:15], s58 offen sc1 lds
    s_add_u32 m0, s65, 4096
    s_add_u32 s58, s27, 32768
    buffer_load_dwordx4 v3, s[12:15], s58 offen sc1 lds
    s_add_u32 m0, s65, 8192
    s_add_u32 s58, s27, 34816
    buffer_load_dwordx4 v3, s[12:15], s58 offen sc1 lds
    s_add_u32 m0, s65, 12288
    s_add_u32 s58, s27, 36864
    buffer_load_dwordx4 v3, s[12:15], s58 offen sc1 lds
    s_add_u32 m0, s65, 16384
    s_add_u32 s58, s27, 38912
    buffer_load_dwordx4 v3, s[12:15], s58 offen sc1 lds
    s_barrier
    s_add_u32 m0, s65, 20480
    s_add_u32 s58, s27, 40960
    buffer_load_dwordx4 v3, s[12:15], s58 offen sc1 lds
    s_add_u32 m0, s65, 24576
    s_add_u32 s58, s27, 43008
    buffer_load_dwordx4 v3, s[12:15], s58 offen sc1 lds
    s_add_u32 m0, s65, 28672
    s_add_u32 s58, s27, 45056
    buffer_load_dwordx4 v3, s[12:15], s58 offen sc1 lds
    s_add_u32 m0, s65, 32768
    s_add_u32 s58, s27, 47104
    buffer_load_dwordx4 v3, s[12:15], s58 offen sc1 lds
    s_add_u32 m0, s65, 36864
    s_add_u32 s58, s27, 49152
    buffer_load_dwordx4 v3, s[12:15], s58 offen sc1 lds
    s_barrier
    buffer_load_dwordx2 v[8:9], v7, s[12:15], 0 offen sc1
    s_add_u32 m0, s65, 40960
    s_add_u32 s58, s27, 51200
    buffer_load_dwordx4 v3, s[12:15], s58 offen sc1 lds
    s_add_u32 m0, s65, 45056
    s_add_u32 s58, s27, 53248
    buffer_load_dwordx4 v3, s[12:15], s58 offen sc1 lds
    s_add_u32 m0, s65, 49152
    s_add_u32 s58, s27, 55296
    buffer_load_dwordx4 v3, s[12:15], s58 offen sc1 lds
    s_add_u32 m0, s65, 53248
    s_add_u32 s58, s27, 57344
    buffer_load_dwordx4 v3, s[12:15], s58 offen sc1 lds
    s_waitcnt vmcnt(10)
    s_barrier
    s_waitcnt vmcnt(4)
    v_cmp_ne_u64 vcc, s[46:47], v[8:9]
    s_cbranch_vccnz Lap_g2_58
Lar_g2_59:
    s_add_u32 m0, s65, 57344
    s_add_u32 s58, s86, 0
    buffer_load_dwordx4 v3, s[16:19], s58 offen sc1 lds
    s_add_u32 m0, s65, 61440
    s_add_u32 s58, s86, 2048
    buffer_load_dwordx4 v3, s[16:19], s58 offen sc1 lds
    s_add_u32 m0, s65, 65536
    s_add_u32 s58, s86, 4096
    buffer_load_dwordx4 v3, s[16:19], s58 offen sc1 lds
    s_add_u32 m0, s65, 69632
    s_add_u32 s58, s86, 6144
    buffer_load_dwordx4 v3, s[16:19], s58 offen sc1 lds
    s_add_u32 m0, s65, 73728
    s_add_u32 s58, s86, 8192
    buffer_load_dwordx4 v3, s[16:19], s58 offen sc1 lds
    s_waitcnt vmcnt(10)
    s_barrier
    s_add_u32 m0, s65, 77824
    s_add_u32 s58, s86, 10240
    buffer_load_dwordx4 v3, s[16:19], s58 offen sc1 lds
    s_add_u32 m0, s65, 81920
    s_add_u32 s58, s86, 12288
    buffer_load_dwordx4 v3, s[16:19], s58 offen sc1 lds
    s_add_u32 m0, s65, 86016
    s_add_u32 s58, s86, 14336
    buffer_load_dwordx4 v3, s[16:19], s58 offen sc1 lds
    s_add_u32 m0, s65, 90112
    s_add_u32 s58, s86, 16384
    buffer_load_dwordx4 v3, s[16:19], s58 offen sc1 lds
    s_add_u32 m0, s65, 94208
    s_add_u32 s58, s86, 18432
    buffer_load_dwordx4 v3, s[16:19], s58 offen sc1 lds
    s_waitcnt vmcnt(10)
    s_barrier
    s_add_u32 m0, s65, 98304
    s_add_u32 s58, s86, 20480
    buffer_load_dwordx4 v3, s[16:19], s58 offen sc1 lds
    s_add_u32 m0, s65, 102400
    s_add_u32 s58, s86, 22528
    buffer_load_dwordx4 v3, s[16:19], s58 offen sc1 lds
    s_waitcnt vmcnt(7)
    s_barrier
    s_add_u32 m0, s65, 106496
    s_add_u32 s58, s86, 24576
    buffer_load_dwordx4 v3, s[16:19], s58 offen sc1 lds
    s_add_u32 m0, s65, 110592
    s_add_u32 s58, s86, 26624
    buffer_load_dwordx4 v3, s[16:19], s58 offen sc1 lds
    s_waitcnt vmcnt(4)
    s_barrier
    s_and_b32 s58, s54, 14
    s_and_b32 s59, s49, 1
    s_add_u32 s58, s58, s59
    s_add_u32 s59, s91, 63872
    s_lshl3_add_u32 s58, s58, s59
    v_mov_b32 v12, s58
    v_and_b32 v13, 15, v1
    v_lshl_add_u32 v13, v13, 3, s59
    s_waitcnt vmcnt(0)
    s_mov_b64 exec, 1
    s_cmp_eq_u32 s30, 0
    s_cbranch_scc1 Lst_60
    buffer_store_dwordx2 v[22:23], v12, s[12:15], 0 offen
Lsr_61:
    s_mov_b64 exec, -1
    s_waitcnt vmcnt(3)
    s_barrier
    s_waitcnt vmcnt(1)
    s_barrier
    buffer_load_dwordx2 v[8:9], v13, s[12:15], 0 offen sc1
    v_lshrrev_b32 v10, 3, v1
    v_and_b32 v11, 7, v1
    v_lshlrev_b32 v5, 4, v11
    v_lshl_add_u32 v5, v10, 10, v5
    v_mul_u32_u24 v6, 272, v10
    v_lshl_add_u32 v6, v11, 5, v6
    s_mul_i32 s58, s48, 2176
    s_add_u32 s58, s58, 114688
    v_add_u32 v6, s58, v6
    s_and_b32 s58, s44, 62
    s_lshl2_add_u32 s58, s58, s48
    s_lshl_b32 s58, s58, 13
    s_and_b32 s59, s45, 14
    s_lshl_b32 s59, s59, 6
    s_add_u32 s62, s58, s59
Lap_fl_62:
    buffer_load_dwordx2 v[26:27], v13, s[12:15], 0 offen sc1
    s_add_u32 s67, s67, 1
    s_cmp_gt_u32 s67, 0x20000
    s_cselect_b64 s[60:61], 0, -1
    s_waitcnt vmcnt(1)
    v_cmp_ne_u64 vcc, s[46:47], v[8:9]
    s_cbranch_vccz Lar_fl_63
    buffer_load_dwordx2 v[8:9], v13, s[12:15], 0 offen sc1
    s_waitcnt vmcnt(1)
    v_cmp_ne_u64 vcc, s[46:47], v[26:27]
    s_nop 0
    s_and_b64 vcc, vcc, s[60:61]
    s_cbranch_scc1 Lap_fl_62
Lar_fl_63:
    s_or_b32 s58, s2, s48
    s_cselect_b32 s58, 1073741824, 0
    v_mov_b32 v12, s58
    s_mov_b64 exec, 1
    buffer_store_dwordx2 v[22:23], v12, s[12:15], 0 offen
    s_mov_b64 exec, -1
    s_barrier
    ds_read_b128 v[192:195], v6 offset:0
    ds_read_b128 v[200:203], v6 offset:17408
    ds_read_b128 v[196:199], v6 offset:16
    ds_read_b128 v[204:207], v6 offset:17424
    s_waitcnt lgkmcnt(2)
    v_pk_add_f32 v[192:193], v[192:193], v[200:201]
    v_pk_add_f32 v[194:195], v[194:195], v[202:203]
    v_cvt_pk_bf16_f32 v208, v192, v193
    v_cvt_pk_bf16_f32 v209, v194, v195
    s_waitcnt lgkmcnt(0)
    v_pk_add_f32 v[196:197], v[196:197], v[204:205]
    v_pk_add_f32 v[198:199], v[198:199], v[206:207]
    v_cvt_pk_bf16_f32 v210, v196, v197
    v_cvt_pk_bf16_f32 v211, v198, v199
    buffer_store_dwordx4 v[208:211], v5, s[16:19], s62 offen
    s_endpgm
L_c_f1:
    s_barrier
    s_lshl2_add_u32 s58, s49, 101376
    v_mov_b32 v15, s58
    s_movk_i32 s59, 0x400
Lsy_64:
    ds_read_b32 v10, v15
    s_sub_u32 s59, s59, 1
    s_waitcnt lgkmcnt(0)
    s_cbranch_scc1 Lsyd_65
    v_cmp_gt_u32 vcc, 1, v10
    s_cbranch_vccnz Lsy_64
Lsyd_65:
    s_add_u32 s55, s26, 38912
    buffer_load_dwordx4 v[24:27], v3, s[12:15], s55 offen sc1
    s_add_u32 s55, s26, 45056
    buffer_load_dwordx4 v[28:31], v3, s[12:15], s55 offen sc1
    s_add_u32 s55, s26, 51200
    buffer_load_dwordx4 v[32:35], v3, s[12:15], s55 offen sc1
    s_add_u32 s55, s26, 57344
    buffer_load_dwordx4 v[36:39], v3, s[12:15], s55 offen sc1
    s_add_u32 s55, s26, 63488
    buffer_load_dwordx4 v[40:43], v3, s[12:15], s55 offen sc1
    s_add_u32 s55, s26, 69632
    buffer_load_dwordx4 v[44:47], v3, s[12:15], s55 offen sc1
    s_add_u32 s55, s26, 75776
    buffer_load_dwordx4 v[48:51], v3, s[12:15], s55 offen sc1
    s_add_u32 s55, s26, 81920
    buffer_load_dwordx4 v[52:55], v3, s[12:15], s55 offen sc1
    s_add_u32 s55, s26, 4096
    buffer_load_dwordx4 v[56:59], v3, s[12:15], s55 offen sc1
    s_add_u32 s55, s26, 10240
    buffer_load_dwordx4 v[64:67], v3, s[12:15], s55 offen sc1
    s_add_u32 s55, s26, 16384
    buffer_load_dwordx4 v[68:71], v3, s[12:15], s55 offen sc1
    s_add_u32 s55, s26, 22528
    buffer_load_dwordx4 v[72:75], v3, s[12:15], s55 offen sc1
    s_barrier
    v_bfe_u32 v5, v1, 2, 2
    v_lshrrev_b32 v10, 5, v1
    v_lshl_add_u32 v5, v10, 2, v5
    v_lshrrev_b32 v10, 2, v1
    v_and_b32 v10, 4, v10
    v_and_or_b32 v10, v1, 3, v10
    v_lshlrev_b32 v10, 3, v10
    s_movk_i32 s58, 192
    v_mad_u32_u24 v5, v5, s58, v10
    s_mul_i32 s58, s49, 24576
    v_add_u32 v5, s58, v5
    ds_read_b64_tr_b16 v[128:129], v5 offset:0
    ds_read_b64_tr_b16 v[130:131], v5 offset:1536
    ds_read_b64_tr_b16 v[132:133], v5 offset:3072
    ds_read_b64_tr_b16 v[134:135], v5 offset:4608
    ds_read_b64_tr_b16 v[136:137], v5 offset:6144
    ds_read_b64_tr_b16 v[138:139], v5 offset:7680
    ds_read_b64_tr_b16 v[140:141], v5 offset:9216
    ds_read_b64_tr_b16 v[142:143], v5 offset:10752
    ds_read_b64_tr_b16 v[144:145], v5 offset:12288
    ds_read_b64_tr_b16 v[146:147], v5 offset:13824
    ds_read_b64_tr_b16 v[148:149], v5 offset:15360
    ds_read_b64_tr_b16 v[150:151], v5 offset:16896
    ds_read_b64_tr_b16 v[152:153], v5 offset:18432
    ds_read_b64_tr_b16 v[154:155], v5 offset:19968
    v_mov_b32 v176, 0
    v_mov_b32 v177, 0
    v_mov_b32 v178, 0
    s_barrier
    s_waitcnt lgkmcnt(12)
    v_dot2c_f32_bf16 v176, s3, v128
    v_dot2c_f32_bf16 v176, s3, v129
    v_dot2c_f32_bf16 v176, s3, v130
    v_dot2c_f32_bf16 v176, s3, v131
    ds_read_b64_tr_b16 v[156:157], v5 offset:21504
    ds_read_b64_tr_b16 v[158:159], v5 offset:23040
    s_waitcnt lgkmcnt(12)
    v_dot2c_f32_bf16 v176, s3, v132
    v_dot2c_f32_bf16 v176, s3, v133
    v_dot2c_f32_bf16 v176, s3, v134
    v_dot2c_f32_bf16 v176, s3, v135
    ds_read_b64_tr_b16 v[160:161], v5 offset:64
    ds_read_b64_tr_b16 v[162:163], v5 offset:1600
    s_waitcnt lgkmcnt(12)
    v_dot2c_f32_bf16 v176, s3, v136
    v_dot2c_f32_bf16 v176, s3, v137
    v_dot2c_f32_bf16 v176, s3, v138
    v_dot2c_f32_bf16 v176, s3, v139
    ds_read_b64_tr_b16 v[164:165], v5 offset:3136
    ds_read_b64_tr_b16 v[166:167], v5 offset:4672
    s_waitcnt lgkmcnt(12)
    v_dot2c_f32_bf16 v176, s3, v140
    v_dot2c_f32_bf16 v176, s3, v141
    v_dot2c_f32_bf16 v176, s3, v142
    v_dot2c_f32_bf16 v176, s3, v143
    ds_read_b64_tr_b16 v[128:129], v5 offset:6208
    ds_read_b64_tr_b16 v[130:131], v5 offset:7744
    s_waitcnt lgkmcnt(12)
    v_dot2c_f32_bf16 v176, s3, v144
    v_dot2c_f32_bf16 v176, s3, v145
    v_dot2c_f32_bf16 v176, s3, v146
    v_dot2c_f32_bf16 v176, s3, v147
    ds_read_b64_tr_b16 v[132:133], v5 offset:9280
    ds_read_b64_tr_b16 v[134:135], v5 offset:10816
    s_waitcnt lgkmcnt(12)
    v_dot2c_f32_bf16 v176, s3, v148
    v_dot2c_f32_bf16 v176, s3, v149
    v_dot2c_f32_bf16 v176, s3, v150
    v_dot2c_f32_bf16 v176, s3, v151
    ds_read_b64_tr_b16 v[136:137], v5 offset:12352
    ds_read_b64_tr_b16 v[138:139], v5 offset:13888
    s_waitcnt lgkmcnt(12)
    v_dot2c_f32_bf16 v176, s3, v152
    v_dot2c_f32_bf16 v176, s3, v153
    v_dot2c_f32_bf16 v176, s3, v154
    v_dot2c_f32_bf16 v176, s3, v155
    ds_read_b64_tr_b16 v[140:141], v5 offset:15424
    ds_read_b64_tr_b16 v[142:143], v5 offset:16960
    s_waitcnt lgkmcnt(12)
    v_dot2c_f32_bf16 v176, s3, v156
    v_dot2c_f32_bf16 v176, s3, v157
    v_dot2c_f32_bf16 v176, s3, v158
    v_dot2c_f32_bf16 v176, s3, v159
    ds_read_b64_tr_b16 v[144:145], v5 offset:18496
    ds_read_b64_tr_b16 v[146:147], v5 offset:20032
    s_waitcnt lgkmcnt(12)
    v_dot2c_f32_bf16 v177, s3, v160
    v_dot2c_f32_bf16 v177, s3, v161
    v_dot2c_f32_bf16 v177, s3, v162
    v_dot2c_f32_bf16 v177, s3, v163
    ds_read_b64_tr_b16 v[148:149], v5 offset:21568
    ds_read_b64_tr_b16 v[150:151], v5 offset:23104
    s_waitcnt lgkmcnt(12)
    v_dot2c_f32_bf16 v177, s3, v164
    v_dot2c_f32_bf16 v177, s3, v165
    v_dot2c_f32_bf16 v177, s3, v166
    v_dot2c_f32_bf16 v177, s3, v167
    ds_read_b64_tr_b16 v[152:153], v5 offset:128
    ds_read_b64_tr_b16 v[154:155], v5 offset:1664
    s_waitcnt lgkmcnt(12)
    v_dot2c_f32_bf16 v177, s3, v128
    v_dot2c_f32_bf16 v177, s3, v129
    v_dot2c_f32_bf16 v177, s3, v130
    v_dot2c_f32_bf16 v177, s3, v131
    ds_read_b64_tr_b16 v[156:157], v5 offset:3200
    ds_read_b64_tr_b16 v[158:159], v5 offset:4736
    s_waitcnt lgkmcnt(12)
    v_dot2c_f32_bf16 v177, s3, v132
    v_dot2c_f32_bf16 v177, s3, v133
    v_dot2c_f32_bf16 v177, s3, v134
    v_dot2c_f32_bf16 v177, s3, v135
    ds_read_b64_tr_b16 v[160:161], v5 offset:6272
    ds_read_b64_tr_b16 v[162:163], v5 offset:7808
    s_waitcnt lgkmcnt(12)
    v_dot2c_f32_bf16 v177, s3, v136
    v_dot2c_f32_bf16 v177, s3, v137
    v_dot2c_f32_bf16 v177, s3, v138
    v_dot2c_f32_bf16 v177, s3, v139
    ds_read_b64_tr_b16 v[164:165], v5 offset:9344
    ds_read_b64_tr_b16 v[166:167], v5 offset:10880
    s_waitcnt lgkmcnt(12)
    v_dot2c_f32_bf16 v177, s3, v140
    v_dot2c_f32_bf16 v177, s3, v141
    v_dot2c_f32_bf16 v177, s3, v142
    v_dot2c_f32_bf16 v177, s3, v143
    ds_read_b64_tr_b16 v[128:129], v5 offset:12416
    ds_read_b64_tr_b16 v[130:131], v5 offset:13952
    s_waitcnt lgkmcnt(12)
    v_dot2c_f32_bf16 v177, s3, v144
    v_dot2c_f32_bf16 v177, s3, v145
    v_dot2c_f32_bf16 v177, s3, v146
    v_dot2c_f32_bf16 v177, s3, v147
    ds_read_b64_tr_b16 v[132:133], v5 offset:15488
    ds_read_b64_tr_b16 v[134:135], v5 offset:17024
    s_waitcnt lgkmcnt(12)
    v_dot2c_f32_bf16 v177, s3, v148
    v_dot2c_f32_bf16 v177, s3, v149
    v_dot2c_f32_bf16 v177, s3, v150
    v_dot2c_f32_bf16 v177, s3, v151
    ds_read_b64_tr_b16 v[136:137], v5 offset:18560
    ds_read_b64_tr_b16 v[138:139], v5 offset:20096
    s_waitcnt lgkmcnt(12)
    v_dot2c_f32_bf16 v178, s3, v152
    v_dot2c_f32_bf16 v178, s3, v153
    v_dot2c_f32_bf16 v178, s3, v154
    v_dot2c_f32_bf16 v178, s3, v155
    ds_read_b64_tr_b16 v[140:141], v5 offset:21632
    ds_read_b64_tr_b16 v[142:143], v5 offset:23168
    s_waitcnt lgkmcnt(12)
    v_dot2c_f32_bf16 v178, s3, v156
    v_dot2c_f32_bf16 v178, s3, v157
    v_dot2c_f32_bf16 v178, s3, v158
    v_dot2c_f32_bf16 v178, s3, v159
    s_waitcnt lgkmcnt(10)
    v_dot2c_f32_bf16 v178, s3, v160
    v_dot2c_f32_bf16 v178, s3, v161
    v_dot2c_f32_bf16 v178, s3, v162
    v_dot2c_f32_bf16 v178, s3, v163
    s_waitcnt lgkmcnt(8)
    v_dot2c_f32_bf16 v178, s3, v164
    v_dot2c_f32_bf16 v178, s3, v165
    v_dot2c_f32_bf16 v178, s3, v166
    v_dot2c_f32_bf16 v178, s3, v167
    s_waitcnt lgkmcnt(6)
    v_dot2c_f32_bf16 v178, s3, v128
    v_dot2c_f32_bf16 v178, s3, v129
    v_dot2c_f32_bf16 v178, s3, v130
    v_dot2c_f32_bf16 v178, s3, v131
    s_waitcnt lgkmcnt(4)
    v_dot2c_f32_bf16 v178, s3, v132
    v_dot2c_f32_bf16 v178, s3, v133
    v_dot2c_f32_bf16 v178, s3, v134
    v_dot2c_f32_bf16 v178, s3, v135
    s_waitcnt lgkmcnt(2)
    v_dot2c_f32_bf16 v178, s3, v136
    v_dot2c_f32_bf16 v178, s3, v137
    v_dot2c_f32_bf16 v178, s3, v138
    v_dot2c_f32_bf16 v178, s3, v139
    s_waitcnt lgkmcnt(0)
    v_dot2c_f32_bf16 v178, s3, v140
    v_dot2c_f32_bf16 v178, s3, v141
    v_dot2c_f32_bf16 v178, s3, v142
    v_dot2c_f32_bf16 v178, s3, v143
    s_lshl2_add_u32 s58, s49, 98304
    v_add_u32 v5, s58, v3
    v_mov_b32 v128, v176
    s_nop 1
    v_permlane32_swap_b32 v128, v176
    v_add_f32 v176, v128, v176
    v_cvt_pk_bf16_f32 v128, v176, v176
    v_and_b32 v128, 0xffff0000, v128
    v_sub_f32 v176, v176, v128
    v_cvt_pk_bf16_f32 v176, v128, v176
    s_cmp_eq_u32 s49, 0
    s_cselect_b32 s58, -1, 0
    s_mov_b32 exec_lo, 0
    v_and_b32 v176, s58, v0
    s_mov_b32 exec_lo, -1
    ds_write_b32 v5, v176 offset:0
    v_mov_b32 v128, v177
    s_nop 1
    v_permlane32_swap_b32 v128, v177
    v_add_f32 v177, v128, v177
    v_cvt_pk_bf16_f32 v128, v177, v177
    v_and_b32 v128, 0xffff0000, v128
    v_sub_f32 v177, v177, v128
    v_cvt_pk_bf16_f32 v177, v128, v177
    s_cmp_eq_u32 s49, 1
    s_cselect_b32 s58, -1, 0
    s_mov_b32 exec_lo, 0
    v_and_b32 v177, s58, v0
    s_mov_b32 exec_lo, -1
    ds_write_b32 v5, v177 offset:1024
    v_mov_b32 v128, v178
    s_nop 1
    v_permlane32_swap_b32 v128, v178
    v_add_f32 v178, v128, v178
    v_cvt_pk_bf16_f32 v128, v178, v178
    v_and_b32 v128, 0xffff0000, v128
    v_sub_f32 v178, v178, v128
    v_cvt_pk_bf16_f32 v178, v128, v178
    s_cmp_eq_u32 s49, 2
    s_cselect_b32 s58, -1, 0
    s_mov_b32 exec_lo, 0
    v_and_b32 v178, s58, v0
    s_mov_b32 exec_lo, -1
    ds_write_b32 v5, v178 offset:2048
    s_waitcnt lgkmcnt(0)
    v_mov_b32 v10, 1
    ds_write_b32 v15, v10 offset:16
    s_and_b32 s59, s49, 1
    s_lshl_b32 s59, s59, 10
    s_add_u32 s27, s91, s59
    s_lshl_b32 s86, s44, 15
    s_add_u32 s86, s86, s59
    s_lshl_b32 s65, s49, 10
    s_add_u32 s58, s65, 106496
    v_add_u32 v5, s58, v3
    ds_read_b128 v[160:163], v5
    ds_read_b128 v[164:167], v5 offset:4096
    v_min_u32 v4, 14, v1
    v_mul_u32_u24 v4, 24, v4
    s_add_u32 s58, s91, 64000
    v_add_u32 v4, s58, v4
    s_waitcnt lgkmcnt(0)
    v_lshlrev_b32 v128, 16, v160
    v_and_b32 v129, 0xffff0000, v160
    v_lshlrev_b32 v176, 16, v16
    v_and_b32 v177, 0xffff0000, v16
    v_add_f32 v128, v128, v176
    v_add_f32 v129, v129, v177
    v_lshlrev_b32 v130, 16, v161
    v_and_b32 v131, 0xffff0000, v161
    v_lshlrev_b32 v176, 16, v17
    v_and_b32 v177, 0xffff0000, v17
    v_add_f32 v130, v130, v176
    v_add_f32 v131, v131, v177
    v_lshlrev_b32 v132, 16, v162
    v_and_b32 v133, 0xffff0000, v162
    v_lshlrev_b32 v176, 16, v18
    v_and_b32 v177, 0xffff0000, v18
    v_add_f32 v132, v132, v176
    v_add_f32 v133, v133, v177
    v_lshlrev_b32 v134, 16, v163
    v_and_b32 v135, 0xffff0000, v163
    v_lshlrev_b32 v176, 16, v19
    v_and_b32 v177, 0xffff0000, v19
    v_add_f32 v134, v134, v176
    v_add_f32 v135, v135, v177
    v_lshlrev_b32 v136, 16, v164
    v_and_b32 v137, 0xffff0000, v164
    v_lshlrev_b32 v176, 16, v20
    v_and_b32 v177, 0xffff0000, v20
    v_add_f32 v136, v136, v176
    v_add_f32 v137, v137, v177
    v_lshlrev_b32 v138, 16, v165
    v_and_b32 v139, 0xffff0000, v165
    v_lshlrev_b32 v176, 16, v21
    v_and_b32 v177, 0xffff0000, v21
    v_add_f32 v138, v138, v176
    v_add_f32 v139, v139, v177
    v_lshlrev_b32 v140, 16, v166
    v_and_b32 v141, 0xffff0000, v166
    v_lshlrev_b32 v176, 16, v6
    v_and_b32 v177, 0xffff0000, v6
    v_add_f32 v140, v140, v176
    v_add_f32 v141, v141, v177
    v_lshlrev_b32 v142, 16, v167
    v_and_b32 v143, 0xffff0000, v167
    v_lshlrev_b32 v176, 16, v7
    v_and_b32 v177, 0xffff0000, v7
    v_add_f32 v142, v142, v176
    v_add_f32 v143, v143, v177
    s_lshr_b32 s58, s49, 1
    s_mul_i32 s59, s58, 3072
    v_add_u32 v16, s59, v3
    v_xor_b32 v19, 0x800, v16
    v_add_u32 v17, 65536, v16
    v_add_u32 v20, 65536, v19
    v_add_u32 v18, 131072, v16
    v_add_u32 v21, 131072, v19
    v_and_b32 v5, 31, v1
    v_lshlrev_b32 v5, 10, v5
    v_lshrrev_b32 v6, 5, v1
    v_lshl_add_u32 v5, v6, 4, v5
    s_lshl_b32 s58, s44, 15
    s_lshl_b32 s59, s45, 6
    s_add_u32 s62, s58, s59
    s_lshl_b32 s58, s49, 12
    s_add_u32 s59, s58, 114688
    v_add_u32 v6, s59, v3
    v_xor_b32 v7, 0x2000, v6
    v_lshrrev_b32 v10, 3, v1
    v_and_b32 v11, 7, v1
    v_lshlrev_b32 v5, 4, v11
    v_lshl_add_u32 v5, v10, 10, v5
    v_mul_u32_u24 v6, 272, v10
    v_lshl_add_u32 v6, v11, 5, v6
    s_mul_i32 s58, s48, 2176
    s_add_u32 s58, s58, 114688
    v_add_u32 v6, s58, v6
    s_and_b32 s58, s44, 62
    s_lshl2_add_u32 s58, s58, s48
    s_lshl_b32 s58, s58, 13
    s_and_b32 s59, s45, 14
    s_lshl_b32 s59, s59, 6
    s_add_u32 s62, s58, s59
    v_and_b32 v10, 31, v1
    v_mul_u32_u24 v10, 272, v10
    v_lshrrev_b32 v11, 5, v1
    v_lshl_add_u32 v10, v11, 4, v10
    s_lshr_b32 s58, s49, 1
    s_and_b32 s59, s49, 1
    s_lshl_b32 s59, s59, 7
    s_add_u32 s59, s59, 114688
    s_mul_i32 s60, s58, 26112
    s_add_u32 s60, s60, s59
    v_add_u32 v12, s60, v10
    s_mul_i32 s60, s58, 8704
    s_add_u32 s60, s60, s59
    s_add_u32 s60, s60, 8704
    v_add_u32 v13, s60, v10
    s_movk_i32 s59, 0x400
Lsy_66:
    ds_read_b32 v10, v15
    s_sub_u32 s59, s59, 1
    s_waitcnt lgkmcnt(0)
    s_cbranch_scc1 Lsyd_67
    v_cmp_gt_u32 vcc, 2, v10
    s_cbranch_vccnz Lsy_66
Lsyd_67:
    s_add_u32 s55, s26, 28672
    buffer_load_dwordx4 v[76:79], v3, s[12:15], s55 offen sc1
    s_add_u32 s55, s26, 34816
    buffer_load_dwordx4 v[80:83], v3, s[12:15], s55 offen sc1
    s_add_u32 s55, s26, 40960
    buffer_load_dwordx4 v[84:87], v3, s[12:15], s55 offen sc1
    s_add_u32 s55, s26, 47104
    buffer_load_dwordx4 v[88:91], v3, s[12:15], s55 offen sc1
    s_add_u32 s55, s26, 53248
    buffer_load_dwordx4 v[92:95], v3, s[12:15], s55 offen sc1
    s_add_u32 s55, s26, 59392
    buffer_load_dwordx4 v[96:99], v3, s[12:15], s55 offen sc1
    s_add_u32 s55, s26, 65536
    buffer_load_dwordx4 v[100:103], v3, s[12:15], s55 offen sc1
    s_add_u32 s55, s26, 71680
    buffer_load_dwordx4 v[104:107], v3, s[12:15], s55 offen sc1
    s_add_u32 s55, s26, 77824
    buffer_load_dwordx4 v[108:111], v3, s[12:15], s55 offen sc1
    s_add_u32 s55, s26, 83968
    buffer_load_dwordx4 v[184:187], v3, s[12:15], s55 offen sc1
    s_movk_i32 s59, 0x400
Lsy_68:
    ds_read_b32 v10, v15
    s_sub_u32 s59, s59, 1
    s_waitcnt lgkmcnt(0)
    s_cbranch_scc1 Lsyd_69
    v_cmp_gt_u32 vcc, 3, v10
    s_cbranch_vccnz Lsy_68
Lsyd_69:
    buffer_load_dwordx2 v[8:9], v4, s[12:15], 0 offen sc1
Lap_g0_70:
    buffer_load_dwordx2 v[188:189], v4, s[12:15], 0 offen sc1
    s_add_u32 s67, s67, 1
    s_cmp_gt_u32 s67, 0x20000
    s_cselect_b64 s[60:61], 0, -1
    s_waitcnt vmcnt(1)
    v_cmp_ne_u64 vcc, s[46:47], v[8:9]
    s_cbranch_vccz Lar_g0_71
    buffer_load_dwordx2 v[8:9], v4, s[12:15], 0 offen sc1
    s_waitcnt vmcnt(1)
    v_cmp_ne_u64 vcc, s[46:47], v[188:189]
    s_nop 0
    s_and_b64 vcc, vcc, s[60:61]
    s_cbranch_scc1 Lap_g0_70
Lar_g0_71:
    s_add_u32 m0, s65, 102400
    s_add_u32 s58, s27, 0
    buffer_load_dwordx4 v3, s[12:15], s58 offen sc1 lds
    s_add_u32 m0, s65, 106496
    s_add_u32 s58, s27, 2048
    buffer_load_dwordx4 v3, s[12:15], s58 offen sc1 lds
    s_add_u32 m0, s65, 110592
    s_add_u32 s58, s27, 4096
    buffer_load_dwordx4 v3, s[12:15], s58 offen sc1 lds
    s_add_u32 m0, s65, 114688
    s_add_u32 s58, s27, 6144
    buffer_load_dwordx4 v3, s[12:15], s58 offen sc1 lds
    s_add_u32 m0, s65, 118784
    s_add_u32 s58, s27, 8192
    buffer_load_dwordx4 v3, s[12:15], s58 offen sc1 lds
    s_add_u32 m0, s65, 122880
    s_add_u32 s58, s27, 10240
    buffer_load_dwordx4 v3, s[12:15], s58 offen sc1 lds
    s_add_u32 m0, s65, 126976
    s_add_u32 s58, s27, 12288
    buffer_load_dwordx4 v3, s[12:15], s58 offen sc1 lds
    s_add_u32 m0, s65, 131072
    s_add_u32 s58, s27, 14336
    buffer_load_dwordx4 v3, s[12:15], s58 offen sc1 lds
    s_add_u32 m0, s65, 135168
    s_add_u32 s58, s27, 16384
    buffer_load_dwordx4 v3, s[12:15], s58 offen sc1 lds
    s_add_u32 m0, s65, 139264
    s_add_u32 s58, s27, 18432
    buffer_load_dwordx4 v3, s[12:15], s58 offen sc1 lds
    s_add_u32 m0, s65, 143360
    s_add_u32 s58, s27, 20480
    buffer_load_dwordx4 v3, s[12:15], s58 offen sc1 lds
    s_add_u32 m0, s65, 147456
    s_add_u32 s58, s27, 22528
    buffer_load_dwordx4 v3, s[12:15], s58 offen sc1 lds
    s_add_u32 m0, s65, 151552
    s_add_u32 s58, s27, 24576
    buffer_load_dwordx4 v3, s[12:15], s58 offen sc1 lds
    s_add_u32 m0, s65, 155648
    s_add_u32 s58, s27, 26624
    buffer_load_dwordx4 v3, s[12:15], s58 offen sc1 lds
    s_add_u32 m0, s65, 159744
    s_add_u32 s58, s27, 28672
    buffer_load_dwordx4 v3, s[12:15], s58 offen sc1 lds
    s_waitcnt vmcnt(10)
    s_barrier
    ds_read_b128 v[160:163], v20 offset:36864
    ds_read_b128 v[164:167], v17 offset:36864
    ds_read_b128 v[168:171], v20 offset:40960
    ds_read_b128 v[172:175], v17 offset:40960
    ds_read_b128 v[176:179], v20 offset:45056
    ds_read_b128 v[180:183], v17 offset:45056
    s_waitcnt lgkmcnt(4)
    v_mfma_f32_32x32x16_bf16 v[144:159], v[192:195], v[160:163], 0
    v_mfma_f32_32x32x16_bf16 v[128:143], v[192:195], v[164:167], v[128:143]
    ds_read_b128 v[160:163], v20 offset:49152
    ds_read_b128 v[164:167], v17 offset:49152
    s_waitcnt lgkmcnt(4)
    v_mfma_f32_32x32x16_bf16 v[144:159], v[196:199], v[168:171], v[144:159]
    v_mfma_f32_32x32x16_bf16 v[128:143], v[196:199], v[172:175], v[128:143]
    ds_read_b128 v[192:195], v20 offset:53248
    ds_read_b128 v[168:171], v17 offset:53248
    s_waitcnt lgkmcnt(4)
    v_mfma_f32_32x32x16_bf16 v[144:159], v[200:203], v[176:179], v[144:159]
    v_mfma_f32_32x32x16_bf16 v[128:143], v[200:203], v[180:183], v[128:143]
    s_waitcnt vmcnt(5)
    s_barrier
    ds_read_b128 v[172:175], v20 offset:57344
    ds_read_b128 v[196:199], v17 offset:57344
    s_waitcnt lgkmcnt(4)
    v_mfma_f32_32x32x16_bf16 v[144:159], v[204:207], v[160:163], v[144:159]
    v_mfma_f32_32x32x16_bf16 v[128:143], v[204:207], v[164:167], v[128:143]
    ds_read_b128 v[176:179], v20 offset:61440
    ds_read_b128 v[180:183], v17 offset:61440
    s_waitcnt lgkmcnt(4)
    v_mfma_f32_32x32x16_bf16 v[144:159], v[208:211], v[192:195], v[144:159]
    v_mfma_f32_32x32x16_bf16 v[128:143], v[208:211], v[168:171], v[128:143]
    ds_read_b128 v[200:203], v21 offset:0
    ds_read_b128 v[160:163], v18 offset:0
    s_waitcnt lgkmcnt(4)
    v_mfma_f32_32x32x16_bf16 v[144:159], v[212:215], v[172:175], v[144:159]
    v_mfma_f32_32x32x16_bf16 v[128:143], v[212:215], v[196:199], v[128:143]
    ds_read_b128 v[164:167], v21 offset:4096
    ds_read_b128 v[204:207], v18 offset:4096
    s_waitcnt lgkmcnt(4)
    v_mfma_f32_32x32x16_bf16 v[144:159], v[216:219], v[176:179], v[144:159]
    v_mfma_f32_32x32x16_bf16 v[128:143], v[216:219], v[180:183], v[128:143]
    ds_read_b128 v[192:195], v21 offset:8192
    ds_read_b128 v[168:171], v18 offset:8192
    s_waitcnt lgkmcnt(4)
    v_mfma_f32_32x32x16_bf16 v[144:159], v[220:223], v[200:203], v[144:159]
    v_mfma_f32_32x32x16_bf16 v[128:143], v[220:223], v[160:163], v[128:143]
    s_waitcnt vmcnt(0)
    s_barrier
    ds_read_b128 v[208:211], v21 offset:12288
    ds_read_b128 v[172:175], v18 offset:12288
    s_waitcnt lgkmcnt(4)
    v_mfma_f32_32x32x16_bf16 v[144:159], v[224:227], v[164:167], v[144:159]
    v_mfma_f32_32x32x16_bf16 v[128:143], v[224:227], v[204:207], v[128:143]
    ds_read_b128 v[196:199], v21 offset:16384
    ds_read_b128 v[212:215], v18 offset:16384
    s_waitcnt lgkmcnt(4)
    v_mfma_f32_32x32x16_bf16 v[144:159], v[228:231], v[192:195], v[144:159]
    v_mfma_f32_32x32x16_bf16 v[128:143], v[228:231], v[168:171], v[128:143]
    ds_read_b128 v[176:179], v21 offset:20480
    ds_read_b128 v[180:183], v18 offset:20480
    s_waitcnt lgkmcnt(4)
    v_mfma_f32_32x32x16_bf16 v[144:159], v[232:235], v[208:211], v[144:159]
    v_mfma_f32_32x32x16_bf16 v[128:143], v[232:235], v[172:175], v[128:143]
    ds_read_b128 v[216:219], v21 offset:24576
    ds_read_b128 v[200:203], v18 offset:24576
    s_waitcnt lgkmcnt(4)
    v_mfma_f32_32x32x16_bf16 v[144:159], v[236:239], v[196:199], v[144:159]
    v_mfma_f32_32x32x16_bf16 v[128:143], v[236:239], v[212:215], v[128:143]
    ds_read_b128 v[160:163], v21 offset:28672
    ds_read_b128 v[220:223], v18 offset:28672
    s_waitcnt lgkmcnt(4)
    v_mfma_f32_32x32x16_bf16 v[144:159], v[240:243], v[176:179], v[144:159]
    v_mfma_f32_32x32x16_bf16 v[128:143], v[240:243], v[180:183], v[128:143]
    s_barrier
    ds_read_b128 v[164:167], v19 offset:0
    ds_read_b128 v[204:207], v16 offset:0
    s_waitcnt lgkmcnt(4)
    v_mfma_f32_32x32x16_bf16 v[144:159], v[244:247], v[216:219], v[144:159]
    v_mfma_f32_32x32x16_bf16 v[128:143], v[244:247], v[200:203], v[128:143]
    ds_read_b128 v[224:227], v19 offset:4096
    ds_read_b128 v[192:195], v16 offset:4096
    s_waitcnt lgkmcnt(4)
    v_mfma_f32_32x32x16_bf16 v[144:159], v[248:251], v[160:163], v[144:159]
    v_mfma_f32_32x32x16_bf16 v[128:143], v[248:251], v[220:223], v[128:143]
    ds_read_b128 v[168:171], v19 offset:8192
    ds_read_b128 v[228:231], v16 offset:8192
    s_waitcnt lgkmcnt(4)
    v_mfma_f32_32x32x16_bf16 v[144:159], v[252:255], v[164:167], v[144:159]
    v_mfma_f32_32x32x16_bf16 v[128:143], v[252:255], v[204:207], v[128:143]
    ds_read_b128 v[208:211], v19 offset:12288
    ds_read_b128 v[172:175], v16 offset:12288
    s_waitcnt lgkmcnt(4)
    v_mfma_f32_32x32x16_bf16 v[144:159], v[60:63], v[224:227], v[144:159]
    v_mfma_f32_32x32x16_bf16 v[128:143], v[60:63], v[192:195], v[128:143]
    ds_read_b128 v[232:235], v19 offset:16384
    ds_read_b128 v[196:199], v16 offset:16384
    s_waitcnt lgkmcnt(4)
    v_mfma_f32_32x32x16_bf16 v[144:159], v[112:115], v[168:171], v[144:159]
    v_mfma_f32_32x32x16_bf16 v[128:143], v[112:115], v[228:231], v[128:143]
    s_barrier
    ds_read_b128 v[212:215], v19 offset:20480
    ds_read_b128 v[236:239], v16 offset:20480
    s_waitcnt lgkmcnt(4)
    v_mfma_f32_32x32x16_bf16 v[144:159], v[116:119], v[208:211], v[144:159]
    v_mfma_f32_32x32x16_bf16 v[128:143], v[116:119], v[172:175], v[128:143]
    ds_read_b128 v[176:179], v19 offset:24576
    ds_read_b128 v[180:183], v16 offset:24576
    s_waitcnt lgkmcnt(4)
    v_mfma_f32_32x32x16_bf16 v[144:159], v[120:123], v[232:235], v[144:159]
    v_mfma_f32_32x32x16_bf16 v[128:143], v[120:123], v[196:199], v[128:143]
    ds_read_b128 v[240:243], v19 offset:28672
    ds_read_b128 v[216:219], v16 offset:28672
    s_waitcnt lgkmcnt(4)
    v_mfma_f32_32x32x16_bf16 v[144:159], v[124:127], v[212:215], v[144:159]
    v_mfma_f32_32x32x16_bf16 v[128:143], v[124:127], v[236:239], v[128:143]
    ds_read_b128 v[200:203], v19 offset:32768
    ds_read_b128 v[244:247], v16 offset:32768
    s_waitcnt lgkmcnt(4)
    v_mfma_f32_32x32x16_bf16 v[144:159], v[24:27], v[176:179], v[144:159]
    v_mfma_f32_32x32x16_bf16 v[128:143], v[24:27], v[180:183], v[128:143]
    ds_read_b128 v[160:163], v19 offset:36864
    ds_read_b128 v[220:223], v16 offset:36864
    s_waitcnt lgkmcnt(4)
    v_mfma_f32_32x32x16_bf16 v[144:159], v[28:31], v[240:243], v[144:159]
    v_mfma_f32_32x32x16_bf16 v[128:143], v[28:31], v[216:219], v[128:143]
    s_barrier
    ds_read_b128 v[248:251], v19 offset:40960
    ds_read_b128 v[164:167], v16 offset:40960
    s_waitcnt lgkmcnt(4)
    v_mfma_f32_32x32x16_bf16 v[144:159], v[32:35], v[200:203], v[144:159]
    v_mfma_f32_32x32x16_bf16 v[128:143], v[32:35], v[244:247], v[128:143]
    ds_read_b128 v[204:207], v19 offset:45056
    ds_read_b128 v[252:255], v16 offset:45056
    s_waitcnt lgkmcnt(4)
    v_mfma_f32_32x32x16_bf16 v[144:159], v[36:39], v[160:163], v[144:159]
    v_mfma_f32_32x32x16_bf16 v[128:143], v[36:39], v[220:223], v[128:143]
    ds_read_b128 v[224:227], v19 offset:49152
    ds_read_b128 v[192:195], v16 offset:49152
    s_waitcnt lgkmcnt(4)
    v_mfma_f32_32x32x16_bf16 v[144:159], v[40:43], v[248:251], v[144:159]
    v_mfma_f32_32x32x16_bf16 v[128:143], v[40:43], v[164:167], v[128:143]
    ds_read_b128 v[60:63], v19 offset:53248
    ds_read_b128 v[168:171], v16 offset:53248
    s_waitcnt lgkmcnt(4)
    v_mfma_f32_32x32x16_bf16 v[144:159], v[44:47], v[204:207], v[144:159]
    v_mfma_f32_32x32x16_bf16 v[128:143], v[44:47], v[252:255], v[128:143]
    s_barrier
    ds_read_b128 v[228:231], v19 offset:57344
    ds_read_b128 v[112:115], v16 offset:57344
    s_waitcnt lgkmcnt(4)
    v_mfma_f32_32x32x16_bf16 v[144:159], v[48:51], v[224:227], v[144:159]
    v_mfma_f32_32x32x16_bf16 v[128:143], v[48:51], v[192:195], v[128:143]
    ds_read_b128 v[208:211], v19 offset:61440
    ds_read_b128 v[172:175], v16 offset:61440
    s_waitcnt lgkmcnt(4)
    v_mfma_f32_32x32x16_bf16 v[144:159], v[52:55], v[60:63], v[144:159]
    v_mfma_f32_32x32x16_bf16 v[128:143], v[52:55], v[168:171], v[128:143]
    ds_read_b128 v[116:119], v20 offset:0
    ds_read_b128 v[232:235], v17 offset:0
    s_waitcnt lgkmcnt(4)
    v_mfma_f32_32x32x16_bf16 v[144:159], v[56:59], v[228:231], v[144:159]
    v_mfma_f32_32x32x16_bf16 v[128:143], v[56:59], v[112:115], v[128:143]
    ds_read_b128 v[196:199], v20 offset:4096
    ds_read_b128 v[120:123], v17 offset:4096
    s_waitcnt lgkmcnt(4)
    v_mfma_f32_32x32x16_bf16 v[144:159], v[64:67], v[208:211], v[144:159]
    v_mfma_f32_32x32x16_bf16 v[128:143], v[64:67], v[172:175], v[128:143]
    ds_read_b128 v[212:215], v20 offset:8192
    ds_read_b128 v[236:239], v17 offset:8192
    s_waitcnt lgkmcnt(4)
    v_mfma_f32_32x32x16_bf16 v[144:159], v[68:71], v[116:119], v[144:159]
    v_mfma_f32_32x32x16_bf16 v[128:143], v[68:71], v[232:235], v[128:143]
    s_barrier
    ds_read_b128 v[124:127], v20 offset:12288
    ds_read_b128 v[176:179], v17 offset:12288
    s_waitcnt lgkmcnt(4)
    v_mfma_f32_32x32x16_bf16 v[144:159], v[72:75], v[196:199], v[144:159]
    v_mfma_f32_32x32x16_bf16 v[128:143], v[72:75], v[120:123], v[128:143]
    ds_read_b128 v[180:183], v20 offset:16384
    ds_read_b128 v[24:27], v17 offset:16384
    s_waitcnt lgkmcnt(4)
    v_mfma_f32_32x32x16_bf16 v[144:159], v[76:79], v[212:215], v[144:159]
    v_mfma_f32_32x32x16_bf16 v[128:143], v[76:79], v[236:239], v[128:143]
    ds_read_b128 v[240:243], v20 offset:20480
    ds_read_b128 v[216:219], v17 offset:20480
    s_waitcnt lgkmcnt(4)
    v_mfma_f32_32x32x16_bf16 v[144:159], v[80:83], v[124:127], v[144:159]
    v_mfma_f32_32x32x16_bf16 v[128:143], v[80:83], v[176:179], v[128:143]
    ds_read_b128 v[28:31], v20 offset:24576
    ds_read_b128 v[200:203], v17 offset:24576
    ds_read_b128 v[244:247], v20 offset:28672
    ds_read_b128 v[32:35], v17 offset:28672
    s_waitcnt lgkmcnt(6)
    v_mfma_f32_32x32x16_bf16 v[144:159], v[84:87], v[180:183], v[144:159]
    v_mfma_f32_32x32x16_bf16 v[128:143], v[84:87], v[24:27], v[128:143]
    s_barrier
    ds_read_b128 v[160:163], v20 offset:32768
    ds_read_b128 v[220:223], v17 offset:32768
    ds_read_b128 v[36:39], v20 offset:36864
    ds_read_b128 v[248:251], v17 offset:36864
    s_waitcnt lgkmcnt(8)
    v_mfma_f32_32x32x16_bf16 v[144:159], v[88:91], v[240:243], v[144:159]
    v_mfma_f32_32x32x16_bf16 v[128:143], v[88:91], v[216:219], v[128:143]
    s_barrier
    ds_read_b128 v[164:167], v20 offset:40960
    ds_read_b128 v[40:43], v17 offset:40960
    s_waitcnt lgkmcnt(8)
    v_mfma_f32_32x32x16_bf16 v[144:159], v[92:95], v[28:31], v[144:159]
    ds_read_b128 v[204:207], v20 offset:45056
    ds_read_b128 v[252:255], v17 offset:45056
    s_waitcnt lgkmcnt(8)
    v_mfma_f32_32x32x16_bf16 v[144:159], v[96:99], v[244:247], v[144:159]
    s_waitcnt lgkmcnt(6)
    v_mfma_f32_32x32x16_bf16 v[144:159], v[100:103], v[160:163], v[144:159]
    s_waitcnt lgkmcnt(4)
    v_mfma_f32_32x32x16_bf16 v[144:159], v[104:107], v[36:39], v[144:159]
    s_waitcnt lgkmcnt(2)
    v_mfma_f32_32x32x16_bf16 v[144:159], v[108:111], v[164:167], v[144:159]
    s_waitcnt lgkmcnt(0)
    v_mfma_f32_32x32x16_bf16 v[144:159], v[184:187], v[204:207], v[144:159]
    v_mfma_f32_32x32x16_bf16 v[128:143], v[92:95], v[200:203], v[128:143]
    v_mfma_f32_32x32x16_bf16 v[128:143], v[96:99], v[32:35], v[128:143]
    v_mfma_f32_32x32x16_bf16 v[128:143], v[100:103], v[220:223], v[128:143]
    s_nop 8
    ds_write_b128 v13, v[144:147] offset:0
    v_mfma_f32_32x32x16_bf16 v[128:143], v[104:107], v[248:251], v[128:143]
    ds_write_b128 v13, v[148:151] offset:32
    v_mfma_f32_32x32x16_bf16 v[128:143], v[108:111], v[40:43], v[128:143]
    ds_write_b128 v13, v[152:155] offset:64
    v_mfma_f32_32x32x16_bf16 v[128:143], v[184:187], v[252:255], v[128:143]
    ds_write_b128 v13, v[156:159] offset:96
    s_nop 10
    ds_write_b128 v12, v[128:131] offset:0
    ds_write_b128 v12, v[132:135] offset:32
    ds_write_b128 v12, v[136:139] offset:64
    ds_write_b128 v12, v[140:143] offset:96
    s_waitcnt lgkmcnt(0)
    s_barrier
    ds_read_b128 v[192:195], v6 offset:0
    ds_read_b128 v[200:203], v6 offset:17408
    ds_read_b128 v[196:199], v6 offset:16
    ds_read_b128 v[204:207], v6 offset:17424
    s_waitcnt lgkmcnt(2)
    v_pk_add_f32 v[192:193], v[192:193], v[200:201]
    v_pk_add_f32 v[194:195], v[194:195], v[202:203]
    v_cvt_pk_bf16_f32 v208, v192, v193
    v_cvt_pk_bf16_f32 v209, v194, v195
    s_waitcnt lgkmcnt(0)
    v_pk_add_f32 v[196:197], v[196:197], v[204:205]
    v_pk_add_f32 v[198:199], v[198:199], v[206:207]
    v_cvt_pk_bf16_f32 v210, v196, v197
    v_cvt_pk_bf16_f32 v211, v198, v199
    buffer_store_dwordx4 v[208:211], v5, s[16:19], s62 offen
L_finish:
L_end:
    s_endpgm
Lpu_1:
    buffer_load_dwordx2 v[8:9], v61, s[12:15], 0 offen sc1
    s_add_u32 s67, s67, 1
    s_cmp_gt_u32 s67, 0x20000
    s_waitcnt vmcnt(0)
    s_cbranch_scc1 Lpr_2
    v_xor_b32 v104, s46, v8
    v_xor_b32 v105, s47, v9
    v_lshrrev_b32 v105, 4, v105
    v_or_b32 v104, v104, v105
    v_cmp_ne_u32 vcc, 0, v104
    s_cbranch_vccnz Lpu_1
    s_branch Lpr_2
Lg1_4:
    buffer_load_dwordx4 v[18:21], v29, s[12:15], 0 offen sc1
    s_add_u32 s67, s67, 1
    s_cmp_gt_u32 s67, 0x20000
    s_waitcnt vmcnt(0)
    s_cbranch_scc1 Lg1r_5
    v_cmp_ne_u64 vcc, s[46:47], v[18:19]
    s_cbranch_vccnz Lg1_4
    s_branch Lg1r_5
Lg1_6:
    buffer_load_dwordx4 v[18:21], v29, s[12:15], 0 offen sc1
    s_add_u32 s67, s67, 1
    s_cmp_gt_u32 s67, 0x20000
    s_waitcnt vmcnt(0)
    s_cbranch_scc1 Lg1r_7
    v_cmp_ne_u64 vcc, s[46:47], v[18:19]
    s_cbranch_vccnz Lg1_6
    s_branch Lg1r_7
Lst_8:
    buffer_store_dwordx2 v[22:23], v12, s[12:15], 0 offen sc1
    s_nop 0
    s_branch Lsr_9
Lsf_14:
    s_add_u32 s67, s67, 1
    s_cmp_gt_u32 s67, 0x20000
    s_cbranch_scc1 Lsfr_15
    s_add_u32 s58, s84, 2
    s_and_b32 s58, s58, 15
    s_lshl_b32 s58, s58, 7
    s_add_u32 s58, s58, s100
    s_load_dwordx2 s[92:93], s[12:13], s58 glc
    s_add_u32 s58, s58, 0x800
    s_load_dwordx2 s[94:95], s[12:13], s58 glc
    s_add_u32 s58, s84, 3
    s_and_b32 s58, s58, 15
    s_lshl_b32 s58, s58, 7
    s_add_u32 s58, s58, s100
    s_load_dwordx2 s[96:97], s[12:13], s58 glc
    s_add_u32 s58, s58, 0x800
    s_load_dwordx2 s[98:99], s[12:13], s58 glc
    s_waitcnt lgkmcnt(0)
    s_xor_b64 s[92:93], s[92:93], s[46:47]
    s_xor_b64 s[94:95], s[94:95], s[46:47]
    s_xor_b64 s[96:97], s[96:97], s[46:47]
    s_xor_b64 s[98:99], s[98:99], s[46:47]
    s_or_b64 s[92:93], s[92:93], s[94:95]
    s_or_b64 s[96:97], s[96:97], s[98:99]
    s_or_b64 s[92:93], s[92:93], s[96:97]
    s_cbranch_scc1 Lsf_14
    s_branch Lsfr_15
Lsf_16:
    s_add_u32 s67, s67, 1
    s_cmp_gt_u32 s67, 0x20000
    s_cbranch_scc1 Lsfr_17
    s_add_u32 s58, s84, 4
    s_and_b32 s58, s58, 15
    s_lshl_b32 s58, s58, 7
    s_add_u32 s58, s58, s100
    s_load_dwordx2 s[92:93], s[12:13], s58 glc
    s_add_u32 s58, s58, 0x800
    s_load_dwordx2 s[94:95], s[12:13], s58 glc
    s_add_u32 s58, s84, 5
    s_and_b32 s58, s58, 15
    s_lshl_b32 s58, s58, 7
    s_add_u32 s58, s58, s100
    s_load_dwordx2 s[96:97], s[12:13], s58 glc
    s_add_u32 s58, s58, 0x800
    s_load_dwordx2 s[98:99], s[12:13], s58 glc
    s_waitcnt lgkmcnt(0)
    s_xor_b64 s[92:93], s[92:93], s[46:47]
    s_xor_b64 s[94:95], s[94:95], s[46:47]
    s_xor_b64 s[96:97], s[96:97], s[46:47]
    s_xor_b64 s[98:99], s[98:99], s[46:47]
    s_or_b64 s[92:93], s[92:93], s[94:95]
    s_or_b64 s[96:97], s[96:97], s[98:99]
    s_or_b64 s[92:93], s[92:93], s[96:97]
    s_cbranch_scc1 Lsf_16
    s_branch Lsfr_17
Lsf_18:
    s_add_u32 s67, s67, 1
    s_cmp_gt_u32 s67, 0x20000
    s_cbranch_scc1 Lsfr_19
    s_add_u32 s58, s84, 6
    s_and_b32 s58, s58, 15
    s_lshl_b32 s58, s58, 7
    s_add_u32 s58, s58, s100
    s_load_dwordx2 s[92:93], s[12:13], s58 glc
    s_add_u32 s58, s58, 0x800
    s_load_dwordx2 s[94:95], s[12:13], s58 glc
    s_add_u32 s58, s84, 7
    s_and_b32 s58, s58, 15
    s_lshl_b32 s58, s58, 7
    s_add_u32 s58, s58, s100
    s_load_dwordx2 s[96:97], s[12:13], s58 glc
    s_add_u32 s58, s58, 0x800
    s_load_dwordx2 s[98:99], s[12:13], s58 glc
    s_waitcnt lgkmcnt(0)
    s_xor_b64 s[92:93], s[92:93], s[46:47]
    s_xor_b64 s[94:95], s[94:95], s[46:47]
    s_xor_b64 s[96:97], s[96:97], s[46:47]
    s_xor_b64 s[98:99], s[98:99], s[46:47]
    s_or_b64 s[92:93], s[92:93], s[94:95]
    s_or_b64 s[96:97], s[96:97], s[98:99]
    s_or_b64 s[92:93], s[92:93], s[96:97]
    s_cbranch_scc1 Lsf_18
    s_branch Lsfr_19
Lsf_20:
    s_add_u32 s67, s67, 1
    s_cmp_gt_u32 s67, 0x20000
    s_cbranch_scc1 Lsfr_21
    s_add_u32 s58, s84, 8
    s_and_b32 s58, s58, 15
    s_lshl_b32 s58, s58, 7
    s_add_u32 s58, s58, s100
    s_load_dwordx2 s[92:93], s[12:13], s58 glc
    s_add_u32 s58, s58, 0x800
    s_load_dwordx2 s[94:95], s[12:13], s58 glc
    s_add_u32 s58, s84, 9
    s_and_b32 s58, s58, 15
    s_lshl_b32 s58, s58, 7
    s_add_u32 s58, s58, s100
    s_load_dwordx2 s[96:97], s[12:13], s58 glc
    s_add_u32 s58, s58, 0x800
    s_load_dwordx2 s[98:99], s[12:13], s58 glc
    s_waitcnt lgkmcnt(0)
    s_xor_b64 s[92:93], s[92:93], s[46:47]
    s_xor_b64 s[94:95], s[94:95], s[46:47]
    s_xor_b64 s[96:97], s[96:97], s[46:47]
    s_xor_b64 s[98:99], s[98:99], s[46:47]
    s_or_b64 s[92:93], s[92:93], s[94:95]
    s_or_b64 s[96:97], s[96:97], s[98:99]
    s_or_b64 s[92:93], s[92:93], s[96:97]
    s_cbranch_scc1 Lsf_20
    s_branch Lsfr_21
Lsf_22:
    s_add_u32 s67, s67, 1
    s_cmp_gt_u32 s67, 0x20000
    s_cbranch_scc1 Lsfr_23
    s_add_u32 s58, s84, 10
    s_and_b32 s58, s58, 15
    s_lshl_b32 s58, s58, 7
    s_add_u32 s58, s58, s100
    s_load_dwordx2 s[92:93], s[12:13], s58 glc
    s_add_u32 s58, s58, 0x800
    s_load_dwordx2 s[94:95], s[12:13], s58 glc
    s_add_u32 s58, s84, 11
    s_and_b32 s58, s58, 15
    s_lshl_b32 s58, s58, 7
    s_add_u32 s58, s58, s100
    s_load_dwordx2 s[96:97], s[12:13], s58 glc
    s_add_u32 s58, s58, 0x800
    s_load_dwordx2 s[98:99], s[12:13], s58 glc
    s_waitcnt lgkmcnt(0)
    s_xor_b64 s[92:93], s[92:93], s[46:47]
    s_xor_b64 s[94:95], s[94:95], s[46:47]
    s_xor_b64 s[96:97], s[96:97], s[46:47]
    s_xor_b64 s[98:99], s[98:99], s[46:47]
    s_or_b64 s[92:93], s[92:93], s[94:95]
    s_or_b64 s[96:97], s[96:97], s[98:99]
    s_or_b64 s[92:93], s[92:93], s[96:97]
    s_cbranch_scc1 Lsf_22
    s_branch Lsfr_23
Lsf_24:
    s_add_u32 s67, s67, 1
    s_cmp_gt_u32 s67, 0x20000
    s_cbranch_scc1 Lsfr_25
    s_add_u32 s58, s84, 12
    s_and_b32 s58, s58, 15
    s_lshl_b32 s58, s58, 7
    s_add_u32 s58, s58, s100
    s_load_dwordx2 s[92:93], s[12:13], s58 glc
    s_add_u32 s58, s58, 0x800
    s_load_dwordx2 s[94:95], s[12:13], s58 glc
    s_add_u32 s58, s84, 13
    s_and_b32 s58, s58, 15
    s_lshl_b32 s58, s58, 7
    s_add_u32 s58, s58, s100
    s_load_dwordx2 s[96:97], s[12:13], s58 glc
    s_add_u32 s58, s58, 0x800
    s_load_dwordx2 s[98:99], s[12:13], s58 glc
    s_waitcnt lgkmcnt(0)
    s_xor_b64 s[92:93], s[92:93], s[46:47]
    s_xor_b64 s[94:95], s[94:95], s[46:47]
    s_xor_b64 s[96:97], s[96:97], s[46:47]
    s_xor_b64 s[98:99], s[98:99], s[46:47]
    s_or_b64 s[92:93], s[92:93], s[94:95]
    s_or_b64 s[96:97], s[96:97], s[98:99]
    s_or_b64 s[92:93], s[92:93], s[96:97]
    s_cbranch_scc1 Lsf_24
    s_branch Lsfr_25
L_fg_stub:
    ds_read_b128 v[124:127], v123
    s_add_u32 s67, s67, 1
    s_cmp_gt_u32 s67, 0x20000
    s_waitcnt lgkmcnt(0)
    s_cbranch_scc1 L_fg_ret
    v_and_b32 v124, v124, v125
    v_and_b32 v126, v126, v127
    v_and_b32 v124, v124, v126
    v_cmp_ne_u32 vcc, 1, v124
    s_cbranch_vccnz L_fg_stub
    s_branch L_fg_ret
Lsf_26:
    s_add_u32 s67, s67, 1
    s_cmp_gt_u32 s67, 0x20000
    s_cbranch_scc1 Lsfr_27
    s_add_u32 s58, s84, 14
    s_and_b32 s58, s58, 15
    s_lshl_b32 s58, s58, 7
    s_add_u32 s58, s58, s100
    s_load_dwordx2 s[92:93], s[12:13], s58 glc
    s_add_u32 s58, s58, 0x800
    s_load_dwordx2 s[94:95], s[12:13], s58 glc
    s_add_u32 s58, s84, 15
    s_and_b32 s58, s58, 15
    s_lshl_b32 s58, s58, 7
    s_add_u32 s58, s58, s100
    s_load_dwordx2 s[96:97], s[12:13], s58 glc
    s_add_u32 s58, s58, 0x800
    s_load_dwordx2 s[98:99], s[12:13], s58 glc
    s_waitcnt lgkmcnt(0)
    s_xor_b64 s[92:93], s[92:93], s[46:47]
    s_xor_b64 s[94:95], s[94:95], s[46:47]
    s_xor_b64 s[96:97], s[96:97], s[46:47]
    s_xor_b64 s[98:99], s[98:99], s[46:47]
    s_or_b64 s[92:93], s[92:93], s[94:95]
    s_or_b64 s[96:97], s[96:97], s[98:99]
    s_or_b64 s[92:93], s[92:93], s[96:97]
    s_cbranch_scc1 Lsf_26
    s_branch Lsfr_27
Lst_28:
    buffer_store_dwordx4 v[76:79], v3, s[12:15], s58 offen sc1
    s_nop 0
    s_branch Lsr_29
Lst_30:
    buffer_store_dwordx2 v[22:23], v14, s[12:15], 0 offen sc1
    s_nop 0
    s_branch Lsr_31
Lst_34:
    buffer_store_dwordx4 v[80:83], v3, s[16:19], s63 offen sc1
    buffer_store_dwordx4 v[84:87], v3, s[16:19], s63 offen offset:1024 sc1
    s_nop 0
    s_branch Lsr_35
Lst_36:
    buffer_store_dwordx2 v[10:11], v3, s[12:15], s64 offen sc1
    s_nop 0
    s_branch Lsr_37
Lst_38:
    buffer_store_dwordx2 v[22:23], v14, s[12:15], 0 offen sc1
    s_nop 0
    s_branch Lsr_39
L_aug_stub:
    ds_read_b128 v[28:31], v8
    s_add_u32 s67, s67, 1
    s_cmp_gt_u32 s67, 0x20000
    s_waitcnt lgkmcnt(0)
    s_cbranch_scc1 L_aug_ret
    v_and_b32 v28, v28, v29
    v_and_b32 v30, v30, v31
    v_and_b32 v28, v28, v30
    v_cmp_ne_u32 vcc, 1, v28
    s_cbranch_vccnz L_aug_stub
    s_branch L_aug_ret
Lst_42:
    buffer_store_dwordx4 v[76:79], v16, s[12:15], 0 offen sc1
    buffer_store_dwordx4 v[80:83], v16, s[12:15], 0 offen offset:1024 sc1
    s_nop 0
    s_branch Lsr_43
Lst_44:
    buffer_store_dwordx2 v[22:23], v19, s[12:15], 0 offen sc1
    s_nop 0
    s_branch Lsr_45
Lst_46:
    buffer_store_dwordx4 v[92:95], v17, s[12:15], 0 offen sc1
    buffer_store_dwordx4 v[96:99], v17, s[12:15], 0 offen offset:1024 sc1
    s_nop 0
    s_branch Lsr_47
Lst_48:
    buffer_store_dwordx2 v[22:23], v20, s[12:15], 0 offen sc1
    s_nop 0
    s_branch Lsr_49
Lap_hd_50:
    buffer_load_dwordx2 v[8:9], v10, s[12:15], 0 offen sc1
    s_add_u32 s67, s67, 1
    s_cmp_gt_u32 s67, 0x20000
    s_waitcnt vmcnt(0)
    s_cbranch_scc1 Lar_hd_51
    v_cmp_ne_u64 vcc, s[46:47], v[8:9]
    s_cbranch_vccnz Lap_hd_50
    s_branch Lar_hd_51
Lst_52:
    buffer_store_dwordx4 v[108:111], v18, s[16:19], 0 offen sc1
    buffer_store_dwordx4 v[112:115], v18, s[16:19], 0 offen offset:1024 sc1
    s_nop 0
    s_branch Lsr_53
Lst_54:
    buffer_store_dwordx2 v[22:23], v21, s[12:15], 0 offen sc1
    s_nop 0
    s_branch Lsr_55
Lap_g1_56:
    buffer_load_dwordx2 v[8:9], v4, s[12:15], 0 offen sc1
    s_add_u32 s67, s67, 1
    s_cmp_gt_u32 s67, 0x20000
    s_waitcnt vmcnt(0)
    s_cbranch_scc1 Lar_g1_57
    v_cmp_ne_u64 vcc, s[46:47], v[8:9]
    s_cbranch_vccnz Lap_g1_56
    s_branch Lar_g1_57
Lap_g2_58:
    buffer_load_dwordx2 v[8:9], v7, s[12:15], 0 offen sc1
    s_add_u32 s67, s67, 1
    s_cmp_gt_u32 s67, 0x20000
    s_waitcnt vmcnt(0)
    s_cbranch_scc1 Lar_g2_59
    v_cmp_ne_u64 vcc, s[46:47], v[8:9]
    s_cbranch_vccnz Lap_g2_58
    s_branch Lar_g2_59
Lst_60:
    buffer_store_dwordx2 v[22:23], v12, s[12:15], 0 offen sc1
    s_nop 0
    s_branch Lsr_61
L_pk_stub:
    buffer_load_dwordx4 v[124:127], v122, s[12:15], 0 offen sc1
    s_add_u32 s67, s67, 1
    s_cmp_gt_u32 s67, 0x20000
    s_waitcnt vmcnt(0)
    s_cbranch_scc1 L_pk_ret
    v_cmp_ne_u64 vcc, s[46:47], v[124:125]
    s_nop 0
    s_mov_b64 s[60:61], vcc
    v_cmp_ne_u64 vcc, s[46:47], v[126:127]
    s_nop 0
    s_or_b64 s[60:61], s[60:61], vcc
    s_cbranch_scc1 L_pk_stub
    s_branch L_pk_ret
L_slow:
    s_waitcnt vmcnt(0) lgkmcnt(0)
    s_barrier
    v_mov_b32 v68, 0
    ds_write_b32 v67, v68
    v_mov_b32 v112, 0xff7fffff
    v_mov_b32 v113, 0xff7fffff
    v_mov_b32 v114, 0xff7fffff
    v_mov_b32 v115, 0xff7fffff
    s_mov_b32 s63, 0
L_slow1:
    s_lshl_b32 s58, s63, 13
    s_add_u32 s58, s58, s68
    buffer_load_dwordx4 v[24:27], v3, s[12:15], s58 offen sc1
    s_waitcnt vmcnt(0)
    v_mfma_f32_32x32x16_bf16 v[64:79], v[24:27], v[96:99], 0
    s_nop 11
    v_max3_f32 v112, v112, v64, v65
    v_max3_f32 v112, v112, v66, v67
    v_max3_f32 v112, v112, v68, v69
    v_max3_f32 v112, v112, v70, v71
    v_max3_f32 v112, v112, v72, v73
    v_max3_f32 v112, v112, v74, v75
    v_max3_f32 v112, v112, v76, v77
    v_max3_f32 v112, v112, v78, v79
    s_nop 1
    v_mfma_f32_32x32x16_bf16 v[64:79], v[24:27], v[100:103], 0
    s_nop 11
    v_max3_f32 v113, v113, v64, v65
    v_max3_f32 v113, v113, v66, v67
    v_max3_f32 v113, v113, v68, v69
    v_max3_f32 v113, v113, v70, v71
    v_max3_f32 v113, v113, v72, v73
    v_max3_f32 v113, v113, v74, v75
    v_max3_f32 v113, v113, v76, v77
    v_max3_f32 v113, v113, v78, v79
    s_nop 1
    v_mfma_f32_32x32x16_bf16 v[64:79], v[24:27], v[104:107], 0
    s_nop 11
    v_max3_f32 v114, v114, v64, v65
    v_max3_f32 v114, v114, v66, v67
    v_max3_f32 v114, v114, v68, v69
    v_max3_f32 v114, v114, v70, v71
    v_max3_f32 v114, v114, v72, v73
    v_max3_f32 v114, v114, v74, v75
    v_max3_f32 v114, v114, v76, v77
    v_max3_f32 v114, v114, v78, v79
    s_nop 1
    v_mfma_f32_32x32x16_bf16 v[64:79], v[24:27], v[108:111], 0
    s_nop 11
    v_max3_f32 v115, v115, v64, v65
    v_max3_f32 v115, v115, v66, v67
    v_max3_f32 v115, v115, v68, v69
    v_max3_f32 v115, v115, v70, v71
    v_max3_f32 v115, v115, v72, v73
    v_max3_f32 v115, v115, v74, v75
    v_max3_f32 v115, v115, v76, v77
    v_max3_f32 v115, v115, v78, v79
    s_nop 1
    s_add_u32 s63, s63, 1
    s_cmp_lt_u32 s63, 16
    s_cbranch_scc1 L_slow1
    v_and_b32 v65, 31, v1
    v_mov_b32 v64, v112
    s_nop 1
    v_permlane32_swap_b32 v64, v112
    v_max_f32 v112, v112, v64
    s_add_u32 s58, s49, 1
    s_and_b32 s58, s58, 3
    s_lshl2_add_u32 s58, s50, s58
    s_lshl_b32 s58, s58, 9
    s_add_u32 s58, s58, 108544
    v_lshl_add_u32 v116, v65, 4, s58
    s_lshl_b32 s58, s49, 2
    v_add_u32 v66, s58, v116
    ds_write_b32 v66, v112
    v_mov_b32 v64, v113
    s_nop 1
    v_permlane32_swap_b32 v64, v113
    v_max_f32 v113, v113, v64
    s_add_u32 s58, s49, 2
    s_and_b32 s58, s58, 3
    s_lshl2_add_u32 s58, s50, s58
    s_lshl_b32 s58, s58, 9
    s_add_u32 s58, s58, 108544
    v_lshl_add_u32 v117, v65, 4, s58
    s_lshl_b32 s58, s49, 2
    v_add_u32 v66, s58, v117
    ds_write_b32 v66, v113
    v_mov_b32 v64, v114
    s_nop 1
    v_permlane32_swap_b32 v64, v114
    v_max_f32 v114, v114, v64
    s_add_u32 s58, s49, 3
    s_and_b32 s58, s58, 3
    s_lshl2_add_u32 s58, s50, s58
    s_lshl_b32 s58, s58, 9
    s_add_u32 s58, s58, 108544
    v_lshl_add_u32 v118, v65, 4, s58
    s_lshl_b32 s58, s49, 2
    v_add_u32 v66, s58, v118
    ds_write_b32 v66, v114
    v_mov_b32 v64, v115
    s_nop 1
    v_permlane32_swap_b32 v64, v115
    v_max_f32 v115, v115, v64
    s_add_u32 s58, s49, 4
    s_and_b32 s58, s58, 3
    s_lshl2_add_u32 s58, s50, s58
    s_lshl_b32 s58, s58, 9
    s_add_u32 s58, s58, 108544
    v_lshl_add_u32 v119, v65, 4, s58
    s_lshl_b32 s58, s49, 2
    v_add_u32 v66, s58, v119
    ds_write_b32 v66, v115
    s_waitcnt lgkmcnt(0)
    s_barrier
    ds_read_b128 v[64:67], v116
    ds_read_b128 v[68:71], v117
    ds_read_b128 v[72:75], v118
    ds_read_b128 v[76:79], v119
    s_waitcnt lgkmcnt(0)
    v_max3_f32 v112, v64, v65, v66
    v_max_f32 v112, v112, v67
    v_max3_f32 v113, v68, v69, v70
    v_max_f32 v113, v113, v71
    v_max3_f32 v114, v72, v73, v74
    v_max_f32 v114, v114, v75
    v_max3_f32 v115, v76, v77, v78
    v_max_f32 v115, v115, v79
    s_barrier
    v_mov_b32 v64, 0
    v_mov_b32 v65, 0
    v_mov_b32 v66, 0
    v_mov_b32 v67, 0
    s_nop 1
    v_mfma_f32_32x32x16_bf16 v[128:143], v[64:67], v[64:67], 0
    v_mfma_f32_32x32x16_bf16 v[144:159], v[64:67], v[64:67], 0
    v_mfma_f32_32x32x16_bf16 v[160:175], v[64:67], v[64:67], 0
    v_mfma_f32_32x32x16_bf16 v[176:191], v[64:67], v[64:67], 0
    s_mov_b32 s63, 0
L_slow2:
    s_lshl_b32 s58, s63, 13
    s_add_u32 s58, s58, s68
    buffer_load_dwordx4 v[24:27], v3, s[12:15], s58 offen sc1
    s_mov_b64 exec, s[40:41]
    buffer_load_dwordx4 v[28:31], v4, s[12:15], s58 offen offset:1024 sc1
    buffer_load_dwordx4 v[32:35], v4, s[12:15], s58 offen offset:1536 sc1
    s_mov_b64 exec, -1
    s_waitcnt vmcnt(0)
    v_mfma_f32_32x32x16_bf16 v[64:79], v[24:27], v[96:99], 0
    s_nop 11
    v_sub_f32 v64, v64, v112
    v_sub_f32 v65, v65, v112
    v_sub_f32 v66, v66, v112
    v_sub_f32 v67, v67, v112
    v_sub_f32 v68, v68, v112
    v_sub_f32 v69, v69, v112
    v_sub_f32 v70, v70, v112
    v_sub_f32 v71, v71, v112
    v_sub_f32 v72, v72, v112
    v_sub_f32 v73, v73, v112
    v_sub_f32 v74, v74, v112
    v_sub_f32 v75, v75, v112
    v_sub_f32 v76, v76, v112
    v_sub_f32 v77, v77, v112
    v_sub_f32 v78, v78, v112
    v_sub_f32 v79, v79, v112
    v_exp_f32 v64, v64
    v_exp_f32 v65, v65
    v_exp_f32 v66, v66
    v_exp_f32 v67, v67
    v_exp_f32 v68, v68
    v_exp_f32 v69, v69
    v_exp_f32 v70, v70
    v_exp_f32 v71, v71
    v_exp_f32 v72, v72
    v_exp_f32 v73, v73
    v_exp_f32 v74, v74
    v_exp_f32 v75, v75
    v_exp_f32 v76, v76
    v_exp_f32 v77, v77
    v_exp_f32 v78, v78
    v_exp_f32 v79, v79
    v_smfmac_f32_32x32x32_bf16 v[128:143], v[28:31], v[64:71], v2
    s_nop 0
    v_smfmac_f32_32x32x32_bf16 v[128:143], v[32:35], v[72:79], v2
    v_mfma_f32_32x32x16_bf16 v[64:79], v[24:27], v[100:103], 0
    s_nop 11
    v_sub_f32 v64, v64, v113
    v_sub_f32 v65, v65, v113
    v_sub_f32 v66, v66, v113
    v_sub_f32 v67, v67, v113
    v_sub_f32 v68, v68, v113
    v_sub_f32 v69, v69, v113
    v_sub_f32 v70, v70, v113
    v_sub_f32 v71, v71, v113
    v_sub_f32 v72, v72, v113
    v_sub_f32 v73, v73, v113
    v_sub_f32 v74, v74, v113
    v_sub_f32 v75, v75, v113
    v_sub_f32 v76, v76, v113
    v_sub_f32 v77, v77, v113
    v_sub_f32 v78, v78, v113
    v_sub_f32 v79, v79, v113
    v_exp_f32 v64, v64
    v_exp_f32 v65, v65
    v_exp_f32 v66, v66
    v_exp_f32 v67, v67
    v_exp_f32 v68, v68
    v_exp_f32 v69, v69
    v_exp_f32 v70, v70
    v_exp_f32 v71, v71
    v_exp_f32 v72, v72
    v_exp_f32 v73, v73
    v_exp_f32 v74, v74
    v_exp_f32 v75, v75
    v_exp_f32 v76, v76
    v_exp_f32 v77, v77
    v_exp_f32 v78, v78
    v_exp_f32 v79, v79
    v_smfmac_f32_32x32x32_bf16 v[144:159], v[28:31], v[64:71], v2
    s_nop 0
    v_smfmac_f32_32x32x32_bf16 v[144:159], v[32:35], v[72:79], v2
    v_mfma_f32_32x32x16_bf16 v[64:79], v[24:27], v[104:107], 0
    s_nop 11
    v_sub_f32 v64, v64, v114
    v_sub_f32 v65, v65, v114
    v_sub_f32 v66, v66, v114
    v_sub_f32 v67, v67, v114
    v_sub_f32 v68, v68, v114
    v_sub_f32 v69, v69, v114
    v_sub_f32 v70, v70, v114
    v_sub_f32 v71, v71, v114
    v_sub_f32 v72, v72, v114
    v_sub_f32 v73, v73, v114
    v_sub_f32 v74, v74, v114
    v_sub_f32 v75, v75, v114
    v_sub_f32 v76, v76, v114
    v_sub_f32 v77, v77, v114
    v_sub_f32 v78, v78, v114
    v_sub_f32 v79, v79, v114
    v_exp_f32 v64, v64
    v_exp_f32 v65, v65
    v_exp_f32 v66, v66
    v_exp_f32 v67, v67
    v_exp_f32 v68, v68
    v_exp_f32 v69, v69
    v_exp_f32 v70, v70
    v_exp_f32 v71, v71
    v_exp_f32 v72, v72
    v_exp_f32 v73, v73
    v_exp_f32 v74, v74
    v_exp_f32 v75, v75
    v_exp_f32 v76, v76
    v_exp_f32 v77, v77
    v_exp_f32 v78, v78
    v_exp_f32 v79, v79
    v_smfmac_f32_32x32x32_bf16 v[160:175], v[28:31], v[64:71], v2
    s_nop 0
    v_smfmac_f32_32x32x32_bf16 v[160:175], v[32:35], v[72:79], v2
    v_mfma_f32_32x32x16_bf16 v[64:79], v[24:27], v[108:111], 0
    s_nop 11
    v_sub_f32 v64, v64, v115
    v_sub_f32 v65, v65, v115
    v_sub_f32 v66, v66, v115
    v_sub_f32 v67, v67, v115
    v_sub_f32 v68, v68, v115
    v_sub_f32 v69, v69, v115
    v_sub_f32 v70, v70, v115
    v_sub_f32 v71, v71, v115
    v_sub_f32 v72, v72, v115
    v_sub_f32 v73, v73, v115
    v_sub_f32 v74, v74, v115
    v_sub_f32 v75, v75, v115
    v_sub_f32 v76, v76, v115
    v_sub_f32 v77, v77, v115
    v_sub_f32 v78, v78, v115
    v_sub_f32 v79, v79, v115
    v_exp_f32 v64, v64
    v_exp_f32 v65, v65
    v_exp_f32 v66, v66
    v_exp_f32 v67, v67
    v_exp_f32 v68, v68
    v_exp_f32 v69, v69
    v_exp_f32 v70, v70
    v_exp_f32 v71, v71
    v_exp_f32 v72, v72
    v_exp_f32 v73, v73
    v_exp_f32 v74, v74
    v_exp_f32 v75, v75
    v_exp_f32 v76, v76
    v_exp_f32 v77, v77
    v_exp_f32 v78, v78
    v_exp_f32 v79, v79
    v_smfmac_f32_32x32x32_bf16 v[176:191], v[28:31], v[64:71], v2
    s_nop 0
    v_smfmac_f32_32x32x32_bf16 v[176:191], v[32:35], v[72:79], v2
    s_nop 15
    s_add_u32 s63, s63, 1
    s_cmp_lt_u32 s63, 16
    s_cbranch_scc1 L_slow2
    ds_write_b128 v10, v[128:131]
    ds_write_b128 v10, v[132:135] offset:1024
    v_sub_u32 v137, v10, v15
    ds_write_b32 v137, v136 offset:2048
    ds_write_b128 v11, v[144:147]
    ds_write_b128 v11, v[148:151] offset:1024
    v_sub_u32 v153, v11, v15
    ds_write_b32 v153, v152 offset:2048
    ds_write_b128 v12, v[160:163]
    ds_write_b128 v12, v[164:167] offset:1024
    v_sub_u32 v169, v12, v15
    ds_write_b32 v169, v168 offset:2048
    s_add_u32 s55, s26, 14336
    buffer_load_dwordx4 v[112:115], v3, s[12:15], s55 offen sc1
    s_add_u32 s55, s26, 20480
    buffer_load_dwordx4 v[116:119], v3, s[12:15], s55 offen sc1
    s_add_u32 s55, s26, 26624
    buffer_load_dwordx4 v[120:123], v3, s[12:15], s55 offen sc1
    s_add_u32 s55, s26, 32768
    buffer_load_dwordx4 v[124:127], v3, s[12:15], s55 offen sc1
    s_waitcnt lgkmcnt(0)
    s_barrier
    s_branch L_reduce
L_code_end:
    s_endpgm
.section .rodata,"a"
.p2align 6
.amdhsa_kernel sequential_preLN__softmax_full_mha__dense_activation_gelu__prompt_kernel
  .amdhsa_next_free_vgpr 256
  .amdhsa_next_free_sgpr 102
  .amdhsa_accum_offset 256
  .amdhsa_group_segment_fixed_size 0
  .amdhsa_kernarg_size 88
  .amdhsa_user_sgpr_count 2
  .amdhsa_user_sgpr_kernarg_segment_ptr 1
  .amdhsa_system_sgpr_workgroup_id_x 1
  .amdhsa_float_denorm_mode_32 3
.end_amdhsa_kernel
```
